```python
import torch

def _softmax(x, axis=-1):
    return torch.softmax(x, dim=axis)
def _gelu(x):
    return torch.nn.functional.gelu(x, approximate="tanh")
def _silu(x):
    return torch.nn.functional.silu(x)
def _sigmoid(x):
    return torch.sigmoid(x)
def _layernorm(x, axis=-1, eps=1e-5):
    m = x.mean(dim=axis, keepdim=True)
    v = x.var(dim=axis, keepdim=True, unbiased=False)
    return (x - m) / torch.sqrt(v + eps)
def _scatter_add(tgt, idx, src, axis=0):
    return tgt.clone().index_add_(axis, idx, src)
def _segment_sum(src, seg, n):
    out = torch.zeros((n,) + src.shape[1:], dtype=src.dtype)
    return out.index_add_(0, seg, src)
def _pad(x, pw):
    flat = tuple(v for pair in reversed(pw) for v in pair)
    return torch.nn.functional.pad(x, flat)

kernel_name = 'concat_heads__mha_block__spectral_fnet__prompt'

def setup_inputs():

    _w = (lambda a: (lambda t: t.to(torch.bfloat16) if t.is_floating_point() else t)(torch.as_tensor(a)))
    def _A_setup():
        B, S, D, H = 1, 2048, 1024, 32
        return {
            "x": _w((lambda *s: torch.randn(*s, dtype=torch.bfloat16) * 0.2)(B, S, D)),
            "wqkv": _w((lambda *s: torch.randn(*s, dtype=torch.bfloat16) * 0.8)(D, 3 * D)),
            "wo": _w((lambda *s: torch.randn(*s, dtype=torch.bfloat16) * 0.2)(D, D)),
        }
    _A_in = _A_setup()

    def _B_setup():
        B, S, D = 1, 2048, 1024
        ns = torch.arange(S)[:, None] * torch.arange(S)[None, :]
        nd = torch.arange(D)[:, None] * torch.arange(D)[None, :]
        Ws_re = torch.cos(-2.0 * torch.pi * ns / S).to(float)
        Ws_im = torch.sin(-2.0 * torch.pi * ns / S).to(float)
        Wd_re = torch.cos(-2.0 * torch.pi * nd / D).to(float)
        Wd_im = torch.sin(-2.0 * torch.pi * nd / D).to(float)
        return {
            "x": _w((lambda *s: torch.randn(*s, dtype=torch.bfloat16) * 0.05)(B, S, D)),
            "dft_seq_re": _w(Ws_re),
            "dft_seq_im": _w(Ws_im),
            "dft_hid_re": _w(Wd_re),
            "dft_hid_im": _w(Wd_im),
        }
    _B_in = _B_setup()

    return {
        "A_x": _A_in["x"],
        "A_wqkv": _A_in["wqkv"],
        "A_wo": _A_in["wo"],
        "B_x": _B_in["x"],
        "B_dft_seq_re": _B_in["dft_seq_re"],
        "B_dft_seq_im": _B_in["dft_seq_im"],
        "B_dft_hid_re": _B_in["dft_hid_re"],
        "B_dft_hid_im": _B_in["dft_hid_im"],
    }

def reference(A_x, A_wqkv, A_wo, B_x, B_dft_seq_re, B_dft_seq_im, B_dft_hid_re, B_dft_hid_im):
    def _A_ref(x, wqkv, wo):
        B, S, D = x.shape
        H = 32
        Dh = D // H
        qkv = (lambda x, *d: x.permute(*d))((x @ wqkv).reshape(B, S, 3, H, Dh), 2, 0, 3, 1, 4)
        q, k, v = qkv[0], qkv[1], qkv[2]
        scores = torch.einsum("bhqd,bhkd->bhqk", q, k) * (Dh ** -0.5)
        p = _softmax(scores, axis=-1)
        o = torch.einsum("bhqk,bhkd->bhqd", p, v)
        return (lambda x, *d: x.permute(*d))(o, 0, 2, 1, 3).reshape(B, S, D) @ wo

    def _B_ref(x, dft_seq_re, dft_seq_im, dft_hid_re, dft_hid_im):
        a = torch.einsum("bsd,ed->bse", x, dft_hid_re)
        b = torch.einsum("bsd,ed->bse", x, dft_hid_im)
        y = torch.einsum("ts,bse->bte", dft_seq_re, a) - torch.einsum("ts,bse->bte", dft_seq_im, b)
        return y

    a = _A_ref(A_x, A_wqkv, A_wo)
    b = _B_ref(B_x, B_dft_seq_re, B_dft_seq_im, B_dft_hid_re, B_dft_hid_im)
    return torch.concatenate([a, b], axis=-1)
```

```asm
; @launch kernel=k1_qkv_kernel grid=(256,1,1) block=(512,1,1) lds=163840
; @launch kernel=k2_attn_kernel grid=(512,1,1) block=(512,1,1) lds=81920
.amdgcn_target "amdgcn-amd-amdhsa--gfx950"
.text
.globl k1_qkv_kernel
.p2align 8
.type k1_qkv_kernel,@function
k1_qkv_kernel:
    s_cmp_ge_u32 s2, 256
    s_cbranch_scc1 K1_END
    s_load_dwordx4 s[4:7], s[0:1], 0
    s_load_dwordx2 s[8:9], s[0:1], 80
    v_lshrrev_b32 v1, 6, v0
    v_and_b32 v2, 63, v0
    s_and_b32 s28, s2, 7
    v_readfirstlane_b32 s24, v1
    s_lshr_b32 s29, s2, 3
    s_and_b32 s30, s29, 7
    s_lshr_b32 s31, s29, 3
    s_and_b32 s25, s28, 1
    s_lshl_b32 s25, s25, 3
    s_add_u32 s25, s25, s30
    s_lshr_b32 s26, s28, 1
    s_lshl_b32 s26, s26, 2
    s_add_u32 s26, s26, s31
    s_lshl_b32 s49, s31, 1
    s_add_u32 s49, s49, s30
    s_mov_b32 s27, 0
    s_cmp_lt_u32 s24, 4
    s_cbranch_scc1 K1_CONS
K1_LOADER:
    s_sub_u32 s34, s24, 4
    v_lshrrev_b32 v3, 2, v2
    v_lshlrev_b32 v3, 11, v3
    v_and_b32 v4, 3, v2
    v_bfe_u32 v5, v2, 4, 2
    v_xor_b32 v4, v4, v5
    v_lshlrev_b32 v4, 4, v4
    v_add_u32 v3, v3, v4
    v_lshrrev_b32 v6, 3, v2
    v_mul_u32_u24 v6, 6144, v6
    v_bfe_u32 v4, v2, 2, 1
    v_bfe_u32 v5, v2, 4, 1
    v_xor_b32 v4, v4, v5
    v_lshlrev_b32 v4, 6, v4
    v_add_u32 v6, v6, v4
    v_and_b32 v4, 3, v2
    v_lshlrev_b32 v4, 4, v4
    v_add_u32 v6, v6, v4
    s_lshl_b32 s36, s25, 18
    s_lshl_b32 s37, s34, 16
    s_add_u32 s36, s36, s37
    s_mul_i32 s37, s34, 8*6144
    s_lshl_b32 s38, s26, 7
    s_add_u32 s37, s37, s38
    s_lshl_b32 s38, s34, 11
    s_lshl_b32 s39, s34, 10
    s_add_u32 s39, s39, 0x2000
    s_mov_b32 s40, 0
    s_waitcnt lgkmcnt(0)
    s_mov_b32 s12, s4
    s_mov_b32 s13, s5
    s_mov_b32 s14, 0x400000
    s_mov_b32 s15, 0x20000
    s_mov_b32 s16, s6
    s_mov_b32 s17, s7
    s_mov_b32 s18, 0x600000
    s_mov_b32 s19, 0x20000
    s_mov_b32 s20, s8
    s_mov_b32 s21, s9
    s_mov_b32 s22, 0x4000000
    s_mov_b32 s23, 0x20000
    s_mov_b32 s41, 3
K1_L0:
    s_add_u32 s47, s27, s49
    s_and_b32 s47, s47, 7
    s_and_b32 s48, s27, 24
    s_or_b32 s47, s47, s48
    s_lshl_b32 s42, s47, 6
    s_add_u32 s42, s42, s36
    s_mul_i32 s43, s47, 32*6144
    s_add_u32 s43, s43, s37
    s_add_u32 m0, s40, s38
    s_add_u32 s44, s42, 32768
    buffer_load_dwordx4 v3, s[12:15], s42 offen lds
    s_add_u32 m0, m0, 1024
    s_add_u32 s45, s43, 2048
    buffer_load_dwordx4 v3, s[12:15], s44 offen lds
    s_add_u32 m0, s40, s39
    s_add_u32 s46, s43, 4096
    buffer_load_dwordx4 v6, s[16:19], s43 offen lds
    s_add_u32 m0, m0, 4096
    s_add_u32 s27, s27, 1
    buffer_load_dwordx4 v6, s[16:19], s45 offen lds
    s_add_u32 m0, m0, 4096
    s_and_b32 s27, s27, 31
    buffer_load_dwordx4 v6, s[16:19], s46 offen lds
    s_add_u32 s40, s40, 20480
    s_cmp_ge_u32 s40, 163840
    s_cselect_b32 s40, 0, s40
    s_sub_u32 s41, s41, 1
    s_cmp_lg_u32 s41, 0
    s_cbranch_scc1 K1_L0
    s_waitcnt vmcnt(10)
    s_barrier
    s_mov_b32 s41, 3
K1_R0:
    s_add_u32 s47, s27, s49
    s_and_b32 s47, s47, 7
    s_and_b32 s48, s27, 24
    s_or_b32 s47, s47, s48
    s_lshl_b32 s42, s47, 6
    s_add_u32 s42, s42, s36
    s_mul_i32 s43, s47, 32*6144
    s_add_u32 s43, s43, s37
    s_add_u32 m0, s40, s38
    s_add_u32 s44, s42, 32768
    buffer_load_dwordx4 v3, s[12:15], s42 offen lds
    s_add_u32 m0, m0, 1024
    s_add_u32 s45, s43, 2048
    buffer_load_dwordx4 v3, s[12:15], s44 offen lds
    s_add_u32 m0, s40, s39
    s_add_u32 s46, s43, 4096
    buffer_load_dwordx4 v6, s[16:19], s43 offen lds
    s_add_u32 m0, m0, 4096
    s_add_u32 s27, s27, 1
    buffer_load_dwordx4 v6, s[16:19], s45 offen lds
    s_add_u32 m0, m0, 4096
    s_and_b32 s27, s27, 31
    buffer_load_dwordx4 v6, s[16:19], s46 offen lds
    s_add_u32 s40, s40, 20480
    s_cmp_ge_u32 s40, 163840
    s_cselect_b32 s40, 0, s40
    s_sub_u32 s41, s41, 1
    s_cmp_lg_u32 s41, 0
    s_cbranch_scc1 K1_R0
    s_waitcnt vmcnt(20)
    s_barrier
    s_mov_b32 s41, 3
K1_R1:
    s_add_u32 s47, s27, s49
    s_and_b32 s47, s47, 7
    s_and_b32 s48, s27, 24
    s_or_b32 s47, s47, s48
    s_lshl_b32 s42, s47, 6
    s_add_u32 s42, s42, s36
    s_mul_i32 s43, s47, 32*6144
    s_add_u32 s43, s43, s37
    s_add_u32 m0, s40, s38
    s_add_u32 s44, s42, 32768
    buffer_load_dwordx4 v3, s[12:15], s42 offen lds
    s_add_u32 m0, m0, 1024
    s_add_u32 s45, s43, 2048
    buffer_load_dwordx4 v3, s[12:15], s44 offen lds
    s_add_u32 m0, s40, s39
    s_add_u32 s46, s43, 4096
    buffer_load_dwordx4 v6, s[16:19], s43 offen lds
    s_add_u32 m0, m0, 4096
    s_add_u32 s27, s27, 1
    buffer_load_dwordx4 v6, s[16:19], s45 offen lds
    s_add_u32 m0, m0, 4096
    s_and_b32 s27, s27, 31
    buffer_load_dwordx4 v6, s[16:19], s46 offen lds
    s_add_u32 s40, s40, 20480
    s_cmp_ge_u32 s40, 163840
    s_cselect_b32 s40, 0, s40
    s_sub_u32 s41, s41, 1
    s_cmp_lg_u32 s41, 0
    s_cbranch_scc1 K1_R1
    s_mov_b32 s41, 23
K1_LLOOP:
    s_waitcnt vmcnt(30)
    s_barrier
    s_add_u32 s47, s27, s49
    s_and_b32 s47, s47, 7
    s_and_b32 s48, s27, 24
    s_or_b32 s47, s47, s48
    s_lshl_b32 s42, s47, 6
    s_add_u32 s42, s42, s36
    s_mul_i32 s43, s47, 32*6144
    s_add_u32 s43, s43, s37
    s_add_u32 m0, s40, s38
    s_add_u32 s44, s42, 32768
    buffer_load_dwordx4 v3, s[12:15], s42 offen lds
    s_add_u32 m0, m0, 1024
    s_add_u32 s45, s43, 2048
    buffer_load_dwordx4 v3, s[12:15], s44 offen lds
    s_add_u32 m0, s40, s39
    s_add_u32 s46, s43, 4096
    buffer_load_dwordx4 v6, s[16:19], s43 offen lds
    s_add_u32 m0, m0, 4096
    s_add_u32 s27, s27, 1
    buffer_load_dwordx4 v6, s[16:19], s45 offen lds
    s_add_u32 m0, m0, 4096
    s_and_b32 s27, s27, 31
    buffer_load_dwordx4 v6, s[16:19], s46 offen lds
    s_add_u32 s40, s40, 20480
    s_cmp_ge_u32 s40, 163840
    s_cselect_b32 s40, 0, s40
    s_sub_u32 s41, s41, 1
    s_cmp_lg_u32 s41, 0
    s_cbranch_scc1 K1_LLOOP
    s_load_dwordx2 s[50:51], s[0:1], 24
    s_load_dwordx4 s[52:55], s[0:1], 32
    s_cmp_ge_u32 s29, 16
    s_waitcnt lgkmcnt(0)
    s_cselect_b32 s52, s54, s52
    s_cselect_b32 s53, s55, s53
    s_cmp_lt_u32 s34, 2
    s_cselect_b32 s56, s50, s52
    s_cselect_b32 s57, s51, s53
    s_mov_b32 s58, 0x400000
    s_cselect_b32 s58, s58, 0x800000
    s_mov_b32 s59, 0x20000
    s_and_b32 s60, s29, 15
    s_lshl_b32 s61, s29, 17
    s_lshl_b32 s62, s28, 8
    s_add_u32 s61, s61, s62
    s_lshl_b32 s62, s34, 7
    s_add_u32 s61, s61, s62
    s_lshl_b32 s62, s60, 18
    s_cmp_lt_u32 s34, 2
    s_cselect_b32 s61, s61, s62
    s_cselect_b32 s63, 11, 12
    s_cmp_eq_u32 s34, 3
    s_cselect_b32 s61, 0x400000, s61
    s_cselect_b32 s63, 17, s63
    s_cselect_b32 s60, 31, 63
    v_and_b32 v8, s60, v2
    v_lshlrev_b32 v8, s63, v8
    buffer_load_dword v9, v8, s[56:59], s61 offen
    s_load_dwordx2 s[50:51], s[0:1], 16
    s_lshl_b32 s60, s29, 2
    s_add_u32 s60, s60, s34
    s_lshl_b32 s60, s60, 14
    s_and_b32 s61, s28, 1
    s_lshl_b32 s61, s61, 10
    s_add_u32 s60, s60, s61
    v_lshrrev_b32 v8, 3, v2
    v_lshlrev_b32 v8, 11, v8
    v_and_b32 v10, 7, v2
    v_lshlrev_b32 v10, 7, v10
    v_add_u32 v8, v8, v10
    s_waitcnt lgkmcnt(0)
    s_mov_b32 s56, s50
    s_mov_b32 s57, s51
    s_mov_b32 s58, 0x200000
    s_mov_b32 s59, 0x20000
    buffer_load_dword v9, v8, s[56:59], s60 offen
    s_waitcnt vmcnt(32)
    s_barrier
    s_waitcnt vmcnt(27)
    s_barrier
    s_waitcnt vmcnt(22)
    s_barrier
    s_waitcnt vmcnt(17)
    s_barrier
    s_waitcnt vmcnt(12)
    s_barrier
    s_waitcnt vmcnt(7)
    s_barrier
    s_waitcnt vmcnt(2)
    s_barrier
    s_waitcnt vmcnt(2)
    s_barrier
    s_endpgm
K1_CONS:
    s_waitcnt lgkmcnt(0)
    s_mov_b32 s12, s4
    s_mov_b32 s13, s5
    s_mov_b32 s14, 0x400000
    s_mov_b32 s15, 0x20000
    s_mov_b32 s16, s6
    s_mov_b32 s17, s7
    s_mov_b32 s18, 0x600000
    s_mov_b32 s19, 0x20000
    s_mov_b32 s20, s8
    s_mov_b32 s21, s9
    s_mov_b32 s22, 0x4000000
    s_mov_b32 s23, 0x20000
    s_cmp_eq_u32 s2, 9
    s_cbranch_scc0 K1_NOTAB
    s_cmp_ge_u32 s24, 2
    s_cbranch_scc1 K1_NOTAB
    v_lshlrev_b32 v6, 4, v2
    s_cmp_eq_u32 s24, 1
    s_cbranch_scc1 K1_TAB1
    v_and_b32 v7, 31, v2
    v_lshrrev_b32 v11, 5, v2
    v_cvt_f32_u32 v9, v7
    v_lshlrev_b32 v10, 2, v11
    v_cvt_f32_u32 v10, v10
    v_mul_f32 v4, 0x3d000000, v9
    v_mul_f32 v5, v10, v4
    v_fmamk_f32 v128, v4, 0x0, v5
    v_fract_f32 v128, v128
    v_fmamk_f32 v129, v4, 0x3f800000, v5
    v_fract_f32 v129, v129
    v_fmamk_f32 v130, v4, 0x40000000, v5
    v_fract_f32 v130, v130
    v_fmamk_f32 v131, v4, 0x40400000, v5
    v_fract_f32 v131, v131
    v_fmamk_f32 v132, v4, 0x41000000, v5
    v_fract_f32 v132, v132
    v_fmamk_f32 v133, v4, 0x41100000, v5
    v_fract_f32 v133, v133
    v_fmamk_f32 v134, v4, 0x41200000, v5
    v_fract_f32 v134, v134
    v_fmamk_f32 v135, v4, 0x41300000, v5
    v_fract_f32 v135, v135
    v_fmamk_f32 v136, v4, 0x41800000, v5
    v_fract_f32 v136, v136
    v_fmamk_f32 v137, v4, 0x41880000, v5
    v_fract_f32 v137, v137
    v_fmamk_f32 v138, v4, 0x41900000, v5
    v_fract_f32 v138, v138
    v_fmamk_f32 v139, v4, 0x41980000, v5
    v_fract_f32 v139, v139
    v_fmamk_f32 v140, v4, 0x41c00000, v5
    v_fract_f32 v140, v140
    v_fmamk_f32 v141, v4, 0x41c80000, v5
    v_fract_f32 v141, v141
    v_fmamk_f32 v142, v4, 0x41d00000, v5
    v_fract_f32 v142, v142
    v_fmamk_f32 v143, v4, 0x41d80000, v5
    v_fract_f32 v143, v143
    v_cos_f32 v144, v128
    v_sin_f32 v128, -v128
    v_cos_f32 v145, v129
    v_sin_f32 v129, -v129
    v_cos_f32 v146, v130
    v_sin_f32 v130, -v130
    v_cos_f32 v147, v131
    v_sin_f32 v131, -v131
    v_cos_f32 v148, v132
    v_sin_f32 v132, -v132
    v_cos_f32 v149, v133
    v_sin_f32 v133, -v133
    v_cos_f32 v150, v134
    v_sin_f32 v134, -v134
    v_cos_f32 v151, v135
    v_sin_f32 v135, -v135
    v_cos_f32 v152, v136
    v_sin_f32 v136, -v136
    v_cos_f32 v153, v137
    v_sin_f32 v137, -v137
    v_cos_f32 v154, v138
    v_sin_f32 v138, -v138
    v_cos_f32 v155, v139
    v_sin_f32 v139, -v139
    v_cos_f32 v156, v140
    v_sin_f32 v140, -v140
    v_cos_f32 v157, v141
    v_sin_f32 v141, -v141
    v_cos_f32 v158, v142
    v_sin_f32 v142, -v142
    v_cos_f32 v159, v143
    v_sin_f32 v143, -v143
    s_nop 0
    v_cvt_pk_bf16_f32 v112, v144, v145
    v_cvt_pk_bf16_f32 v120, v128, v129
    v_cvt_pk_bf16_f32 v113, v146, v147
    v_cvt_pk_bf16_f32 v121, v130, v131
    v_cvt_pk_bf16_f32 v114, v148, v149
    v_cvt_pk_bf16_f32 v122, v132, v133
    v_cvt_pk_bf16_f32 v115, v150, v151
    v_cvt_pk_bf16_f32 v123, v134, v135
    v_cvt_pk_bf16_f32 v116, v152, v153
    v_cvt_pk_bf16_f32 v124, v136, v137
    v_cvt_pk_bf16_f32 v117, v154, v155
    v_cvt_pk_bf16_f32 v125, v138, v139
    v_cvt_pk_bf16_f32 v118, v156, v157
    v_cvt_pk_bf16_f32 v126, v140, v141
    v_cvt_pk_bf16_f32 v119, v158, v159
    v_cvt_pk_bf16_f32 v127, v142, v143
    s_mov_b32 s36, 0x2004000
    buffer_store_dwordx4 v[112:115], v6, s[20:23], s36 offen offset:0
    buffer_store_dwordx4 v[116:119], v6, s[20:23], s36 offen offset:1024
    buffer_store_dwordx4 v[120:123], v6, s[20:23], s36 offen offset:2048
    buffer_store_dwordx4 v[124:127], v6, s[20:23], s36 offen offset:3072
    s_branch K1_NOTAB
K1_TAB1:
    v_and_b32 v7, 31, v2
    v_lshrrev_b32 v11, 5, v2
    v_cvt_f32_u32 v9, v7
    v_lshlrev_b32 v10, 2, v11
    v_cvt_f32_u32 v10, v10
    v_mul_f32 v9, 0x3a800000, v9
    v_mul_f32 v10, v10, v9
    v_fmamk_f32 v176, v9, 0x0, v10
    v_fmamk_f32 v177, v9, 0x3f800000, v10
    v_fmamk_f32 v178, v9, 0x40000000, v10
    v_fmamk_f32 v179, v9, 0x40400000, v10
    v_fmamk_f32 v180, v9, 0x41000000, v10
    v_fmamk_f32 v181, v9, 0x41100000, v10
    v_fmamk_f32 v182, v9, 0x41200000, v10
    v_fmamk_f32 v183, v9, 0x41300000, v10
    v_fmamk_f32 v184, v9, 0x41800000, v10
    v_fmamk_f32 v185, v9, 0x41880000, v10
    v_fmamk_f32 v186, v9, 0x41900000, v10
    v_fmamk_f32 v187, v9, 0x41980000, v10
    v_fmamk_f32 v188, v9, 0x41c00000, v10
    v_fmamk_f32 v189, v9, 0x41c80000, v10
    v_fmamk_f32 v190, v9, 0x41d00000, v10
    v_fmamk_f32 v191, v9, 0x41d80000, v10
    v_cos_f32 v160, v176
    v_sin_f32 v176, -v176
    v_cos_f32 v161, v177
    v_sin_f32 v177, -v177
    v_cos_f32 v162, v178
    v_sin_f32 v178, -v178
    v_cos_f32 v163, v179
    v_sin_f32 v179, -v179
    v_cos_f32 v164, v180
    v_sin_f32 v180, -v180
    v_cos_f32 v165, v181
    v_sin_f32 v181, -v181
    v_cos_f32 v166, v182
    v_sin_f32 v182, -v182
    v_cos_f32 v167, v183
    v_sin_f32 v183, -v183
    v_cos_f32 v168, v184
    v_sin_f32 v184, -v184
    v_cos_f32 v169, v185
    v_sin_f32 v185, -v185
    v_cos_f32 v170, v186
    v_sin_f32 v186, -v186
    v_cos_f32 v171, v187
    v_sin_f32 v187, -v187
    v_cos_f32 v172, v188
    v_sin_f32 v188, -v188
    v_cos_f32 v173, v189
    v_sin_f32 v189, -v189
    v_cos_f32 v174, v190
    v_sin_f32 v190, -v190
    v_cos_f32 v175, v191
    v_sin_f32 v191, -v191
    s_nop 0
    s_mov_b32 s36, 0x2005000
    buffer_store_dwordx4 v[160:163], v6, s[20:23], s36 offen offset:0
    buffer_store_dwordx4 v[164:167], v6, s[20:23], s36 offen offset:1024
    buffer_store_dwordx4 v[168:171], v6, s[20:23], s36 offen offset:2048
    buffer_store_dwordx4 v[172:175], v6, s[20:23], s36 offen offset:3072
    s_add_u32 s36, s36, 4096
    buffer_store_dwordx4 v[176:179], v6, s[20:23], s36 offen offset:0
    buffer_store_dwordx4 v[180:183], v6, s[20:23], s36 offen offset:1024
    buffer_store_dwordx4 v[184:187], v6, s[20:23], s36 offen offset:2048
    buffer_store_dwordx4 v[188:191], v6, s[20:23], s36 offen offset:3072
K1_NOTAB:
    s_and_b32 s34, s24, 1
    s_lshr_b32 s35, s24, 1
    v_and_b32 v9, 31, v2
    s_lshl_b32 s36, s34, 6
    v_add_u32 v9, s36, v9
    v_lshlrev_b32 v9, 6, v9
    v_lshrrev_b32 v10, 5, v2
    v_bfe_u32 v11, v2, 2, 2
    v_xor_b32 v10, v10, v11
    v_lshlrev_b32 v10, 4, v10
    v_add_u32 v3, v9, v10
    v_xor_b32 v4, 32, v3
    v_lshrrev_b32 v9, 5, v2
    v_lshlrev_b32 v9, 3, v9
    v_add_u32 v9, v9, v11
    v_lshlrev_b32 v9, 7, v9
    v_lshrrev_b32 v10, 1, v11
    v_xor_b32 v10, s35, v10
    v_lshlrev_b32 v10, 6, v10
    v_add_u32 v9, v9, v10
    v_bfe_u32 v10, v2, 4, 1
    v_lshlrev_b32 v10, 5, v10
    v_add_u32 v9, v9, v10
    v_and_b32 v10, 3, v2
    v_lshlrev_b32 v10, 3, v10
    v_add_u32 v9, v9, v10
    v_add_u32 v5, 0x2000, v9
    v_mov_b32 v16, 0
    v_mov_b32 v17, 0
    v_mov_b32 v18, 0
    v_mov_b32 v19, 0
    v_mov_b32 v20, 0
    v_mov_b32 v21, 0
    v_mov_b32 v22, 0
    v_mov_b32 v23, 0
    v_mov_b32 v24, 0
    v_mov_b32 v25, 0
    v_mov_b32 v26, 0
    v_mov_b32 v27, 0
    v_mov_b32 v28, 0
    v_mov_b32 v29, 0
    v_mov_b32 v30, 0
    v_mov_b32 v31, 0
    v_mov_b32 v32, 0
    v_mov_b32 v33, 0
    v_mov_b32 v34, 0
    v_mov_b32 v35, 0
    v_mov_b32 v36, 0
    v_mov_b32 v37, 0
    v_mov_b32 v38, 0
    v_mov_b32 v39, 0
    v_mov_b32 v40, 0
    v_mov_b32 v41, 0
    v_mov_b32 v42, 0
    v_mov_b32 v43, 0
    v_mov_b32 v44, 0
    v_mov_b32 v45, 0
    v_mov_b32 v46, 0
    v_mov_b32 v47, 0
    v_mov_b32 v48, 0
    v_mov_b32 v49, 0
    v_mov_b32 v50, 0
    v_mov_b32 v51, 0
    v_mov_b32 v52, 0
    v_mov_b32 v53, 0
    v_mov_b32 v54, 0
    v_mov_b32 v55, 0
    v_mov_b32 v56, 0
    v_mov_b32 v57, 0
    v_mov_b32 v58, 0
    v_mov_b32 v59, 0
    v_mov_b32 v60, 0
    v_mov_b32 v61, 0
    v_mov_b32 v62, 0
    v_mov_b32 v63, 0
    v_mov_b32 v64, 0
    v_mov_b32 v65, 0
    v_mov_b32 v66, 0
    v_mov_b32 v67, 0
    v_mov_b32 v68, 0
    v_mov_b32 v69, 0
    v_mov_b32 v70, 0
    v_mov_b32 v71, 0
    v_mov_b32 v72, 0
    v_mov_b32 v73, 0
    v_mov_b32 v74, 0
    v_mov_b32 v75, 0
    v_mov_b32 v76, 0
    v_mov_b32 v77, 0
    v_mov_b32 v78, 0
    v_mov_b32 v79, 0
    v_mov_b32 v80, 0
    v_mov_b32 v81, 0
    v_mov_b32 v82, 0
    v_mov_b32 v83, 0
    v_mov_b32 v84, 0
    v_mov_b32 v85, 0
    v_mov_b32 v86, 0
    v_mov_b32 v87, 0
    v_mov_b32 v88, 0
    v_mov_b32 v89, 0
    v_mov_b32 v90, 0
    v_mov_b32 v91, 0
    v_mov_b32 v92, 0
    v_mov_b32 v93, 0
    v_mov_b32 v94, 0
    v_mov_b32 v95, 0
    v_mov_b32 v96, 0
    v_mov_b32 v97, 0
    v_mov_b32 v98, 0
    v_mov_b32 v99, 0
    v_mov_b32 v100, 0
    v_mov_b32 v101, 0
    v_mov_b32 v102, 0
    v_mov_b32 v103, 0
    v_mov_b32 v104, 0
    v_mov_b32 v105, 0
    v_mov_b32 v106, 0
    v_mov_b32 v107, 0
    v_mov_b32 v108, 0
    v_mov_b32 v109, 0
    v_mov_b32 v110, 0
    v_mov_b32 v111, 0
    s_cmp_lt_u32 s2, 9
    s_cbranch_scc0 K1_NOZ
    s_cmp_eq_u32 s24, 0
    s_cbranch_scc0 K1_NOZ
    v_lshlrev_b32 v9, 4, v2
    s_lshl_b32 s36, s2, 10
    s_add_u32 s36, s36, 0x2000000
    buffer_store_dwordx4 v[16:19], v9, s[20:23], s36 offen
K1_NOZ:
    s_mov_b32 s40, 0
    v_add_u32 v6, s40, v3
    v_add_u32 v7, s40, v4
    v_add_u32 v8, s40, v5
    s_barrier
    ds_read_b128 v[112:115], v6
    ds_read_b64_tr_b16 v[144:145], v8 offset:0
    ds_read_b64_tr_b16 v[146:147], v8 offset:512
    ds_read_b128 v[116:119], v6 offset:2048
    ds_read_b64_tr_b16 v[148:149], v8 offset:4096
    ds_read_b64_tr_b16 v[150:151], v8 offset:4608
    ds_read_b64_tr_b16 v[152:153], v8 offset:8192
    ds_read_b64_tr_b16 v[154:155], v8 offset:8704
    ds_read_b128 v[120:123], v7
    ds_read_b64_tr_b16 v[156:157], v8 offset:2048
    ds_read_b64_tr_b16 v[158:159], v8 offset:2560
    ds_read_b128 v[124:127], v7 offset:2048
    ds_read_b64_tr_b16 v[160:161], v8 offset:6144
    ds_read_b64_tr_b16 v[162:163], v8 offset:6656
    ds_read_b64_tr_b16 v[164:165], v8 offset:10240
    ds_read_b64_tr_b16 v[166:167], v8 offset:10752
    s_add_u32 s40, s40, 20480
    s_cmp_ge_u32 s40, 163840
    s_cselect_b32 s40, 0, s40
    s_mov_b32 s41, 16
    s_waitcnt lgkmcnt(0)
K1_CLOOP:
    v_add_u32 v6, s40, v3
    v_add_u32 v7, s40, v4
    v_add_u32 v8, s40, v5
    s_barrier
    v_mfma_f32_32x32x16_bf16 v[16:31], v[144:147], v[112:115], v[16:31]
    ds_read_b128 v[128:131], v6
    ds_read_b64_tr_b16 v[168:169], v8 offset:0
    v_mfma_f32_32x32x16_bf16 v[64:79], v[144:147], v[116:119], v[64:79]
    ds_read_b64_tr_b16 v[170:171], v8 offset:512
    ds_read_b128 v[132:135], v6 offset:2048
    v_mfma_f32_32x32x16_bf16 v[32:47], v[148:151], v[112:115], v[32:47]
    ds_read_b64_tr_b16 v[172:173], v8 offset:4096
    ds_read_b64_tr_b16 v[174:175], v8 offset:4608
    v_mfma_f32_32x32x16_bf16 v[80:95], v[148:151], v[116:119], v[80:95]
    ds_read_b64_tr_b16 v[176:177], v8 offset:8192
    ds_read_b64_tr_b16 v[178:179], v8 offset:8704
    v_mfma_f32_32x32x16_bf16 v[48:63], v[112:115], v[152:155], v[48:63]
    ds_read_b128 v[136:139], v7
    ds_read_b64_tr_b16 v[180:181], v8 offset:2048
    v_mfma_f32_32x32x16_bf16 v[96:111], v[116:119], v[152:155], v[96:111]
    ds_read_b64_tr_b16 v[182:183], v8 offset:2560
    ds_read_b128 v[140:143], v7 offset:2048
    v_mfma_f32_32x32x16_bf16 v[16:31], v[156:159], v[120:123], v[16:31]
    ds_read_b64_tr_b16 v[184:185], v8 offset:6144
    ds_read_b64_tr_b16 v[186:187], v8 offset:6656
    v_mfma_f32_32x32x16_bf16 v[64:79], v[156:159], v[124:127], v[64:79]
    ds_read_b64_tr_b16 v[188:189], v8 offset:10240
    ds_read_b64_tr_b16 v[190:191], v8 offset:10752
    v_mfma_f32_32x32x16_bf16 v[32:47], v[160:163], v[120:123], v[32:47]
    v_mfma_f32_32x32x16_bf16 v[80:95], v[160:163], v[124:127], v[80:95]
    v_mfma_f32_32x32x16_bf16 v[48:63], v[120:123], v[164:167], v[48:63]
    v_mfma_f32_32x32x16_bf16 v[96:111], v[124:127], v[164:167], v[96:111]
    s_add_u32 s40, s40, 20480
    s_cmp_ge_u32 s40, 163840
    s_cselect_b32 s40, 0, s40
    s_waitcnt lgkmcnt(0)
    v_add_u32 v6, s40, v3
    v_add_u32 v7, s40, v4
    v_add_u32 v8, s40, v5
    s_barrier
    v_mfma_f32_32x32x16_bf16 v[16:31], v[168:171], v[128:131], v[16:31]
    ds_read_b128 v[112:115], v6
    ds_read_b64_tr_b16 v[144:145], v8 offset:0
    v_mfma_f32_32x32x16_bf16 v[64:79], v[168:171], v[132:135], v[64:79]
    ds_read_b64_tr_b16 v[146:147], v8 offset:512
    ds_read_b128 v[116:119], v6 offset:2048
    v_mfma_f32_32x32x16_bf16 v[32:47], v[172:175], v[128:131], v[32:47]
    ds_read_b64_tr_b16 v[148:149], v8 offset:4096
    ds_read_b64_tr_b16 v[150:151], v8 offset:4608
    v_mfma_f32_32x32x16_bf16 v[80:95], v[172:175], v[132:135], v[80:95]
    ds_read_b64_tr_b16 v[152:153], v8 offset:8192
    ds_read_b64_tr_b16 v[154:155], v8 offset:8704
    v_mfma_f32_32x32x16_bf16 v[48:63], v[128:131], v[176:179], v[48:63]
    ds_read_b128 v[120:123], v7
    ds_read_b64_tr_b16 v[156:157], v8 offset:2048
    v_mfma_f32_32x32x16_bf16 v[96:111], v[132:135], v[176:179], v[96:111]
    ds_read_b64_tr_b16 v[158:159], v8 offset:2560
    ds_read_b128 v[124:127], v7 offset:2048
    v_mfma_f32_32x32x16_bf16 v[16:31], v[180:183], v[136:139], v[16:31]
    ds_read_b64_tr_b16 v[160:161], v8 offset:6144
    ds_read_b64_tr_b16 v[162:163], v8 offset:6656
    v_mfma_f32_32x32x16_bf16 v[64:79], v[180:183], v[140:143], v[64:79]
    ds_read_b64_tr_b16 v[164:165], v8 offset:10240
    ds_read_b64_tr_b16 v[166:167], v8 offset:10752
    v_mfma_f32_32x32x16_bf16 v[32:47], v[184:187], v[136:139], v[32:47]
    v_mfma_f32_32x32x16_bf16 v[80:95], v[184:187], v[140:143], v[80:95]
    v_mfma_f32_32x32x16_bf16 v[48:63], v[136:139], v[188:191], v[48:63]
    v_mfma_f32_32x32x16_bf16 v[96:111], v[140:143], v[188:191], v[96:111]
    s_add_u32 s40, s40, 20480
    s_cmp_ge_u32 s40, 163840
    s_cselect_b32 s40, 0, s40
    s_sub_u32 s41, s41, 1
    s_cmp_lg_u32 s41, 0
    s_waitcnt lgkmcnt(0)
    s_cbranch_scc1 K1_CLOOP
    s_nop 15
    v_lshlrev_b32 v9, 4, v2
    s_lshl_b32 s42, s26, 1
    s_add_u32 s42, s42, s35
    s_lshl_b32 s42, s42, 6
    s_lshl_b32 s43, s25, 2
    s_lshl_b32 s44, s34, 1
    s_add_u32 s42, s42, s43
    s_add_u32 s42, s42, s44
    s_lshl_b32 s43, s42, 12
    s_lshl_b32 s42, s42, 11
    s_mov_b32 s45, 0x3e8293ee
    v_mul_f32 v16, s45, v16
    v_mul_f32 v17, s45, v17
    v_mul_f32 v18, s45, v18
    v_mul_f32 v19, s45, v19
    v_mul_f32 v20, s45, v20
    v_mul_f32 v21, s45, v21
    v_mul_f32 v22, s45, v22
    v_mul_f32 v23, s45, v23
    v_mul_f32 v24, s45, v24
    v_mul_f32 v25, s45, v25
    v_mul_f32 v26, s45, v26
    v_mul_f32 v27, s45, v27
    v_mul_f32 v28, s45, v28
    v_mul_f32 v29, s45, v29
    v_mul_f32 v30, s45, v30
    v_mul_f32 v31, s45, v31
    v_cvt_pk_bf16_f32 v16, v16, v17
    v_cvt_pk_bf16_f32 v17, v18, v19
    v_cvt_pk_bf16_f32 v18, v20, v21
    v_cvt_pk_bf16_f32 v19, v22, v23
    v_cvt_pk_bf16_f32 v20, v24, v25
    v_cvt_pk_bf16_f32 v21, v26, v27
    v_cvt_pk_bf16_f32 v22, v28, v29
    v_cvt_pk_bf16_f32 v23, v30, v31
    s_add_u32 s46, s42, 0x0
    buffer_store_dwordx4 v[16:19], v9, s[20:23], s46 offen sc1
    buffer_store_dwordx4 v[20:23], v9, s[20:23], s46 offen offset:1024 sc1
    v_mul_f32 v64, s45, v64
    v_mul_f32 v65, s45, v65
    v_mul_f32 v66, s45, v66
    v_mul_f32 v67, s45, v67
    v_mul_f32 v68, s45, v68
    v_mul_f32 v69, s45, v69
    v_mul_f32 v70, s45, v70
    v_mul_f32 v71, s45, v71
    v_mul_f32 v72, s45, v72
    v_mul_f32 v73, s45, v73
    v_mul_f32 v74, s45, v74
    v_mul_f32 v75, s45, v75
    v_mul_f32 v76, s45, v76
    v_mul_f32 v77, s45, v77
    v_mul_f32 v78, s45, v78
    v_mul_f32 v79, s45, v79
    v_cvt_pk_bf16_f32 v64, v64, v65
    v_cvt_pk_bf16_f32 v65, v66, v67
    v_cvt_pk_bf16_f32 v66, v68, v69
    v_cvt_pk_bf16_f32 v67, v70, v71
    v_cvt_pk_bf16_f32 v68, v72, v73
    v_cvt_pk_bf16_f32 v69, v74, v75
    v_cvt_pk_bf16_f32 v70, v76, v77
    v_cvt_pk_bf16_f32 v71, v78, v79
    s_add_u32 s46, s42, 0x800
    buffer_store_dwordx4 v[64:67], v9, s[20:23], s46 offen sc1
    buffer_store_dwordx4 v[68:71], v9, s[20:23], s46 offen offset:1024 sc1
    v_cvt_pk_bf16_f32 v32, v32, v33
    v_cvt_pk_bf16_f32 v33, v34, v35
    v_cvt_pk_bf16_f32 v34, v36, v37
    v_cvt_pk_bf16_f32 v35, v38, v39
    v_cvt_pk_bf16_f32 v36, v40, v41
    v_cvt_pk_bf16_f32 v37, v42, v43
    v_cvt_pk_bf16_f32 v38, v44, v45
    v_cvt_pk_bf16_f32 v39, v46, v47
    s_add_u32 s46, s43, 0x400000
    buffer_store_dwordx4 v[32:35], v9, s[20:23], s46 offen sc1
    buffer_store_dwordx4 v[36:39], v9, s[20:23], s46 offen offset:1024 sc1
    v_cvt_pk_bf16_f32 v80, v80, v81
    v_cvt_pk_bf16_f32 v81, v82, v83
    v_cvt_pk_bf16_f32 v82, v84, v85
    v_cvt_pk_bf16_f32 v83, v86, v87
    v_cvt_pk_bf16_f32 v84, v88, v89
    v_cvt_pk_bf16_f32 v85, v90, v91
    v_cvt_pk_bf16_f32 v86, v92, v93
    v_cvt_pk_bf16_f32 v87, v94, v95
    s_add_u32 s46, s43, 0x401000
    buffer_store_dwordx4 v[80:83], v9, s[20:23], s46 offen sc1
    buffer_store_dwordx4 v[84:87], v9, s[20:23], s46 offen offset:1024 sc1
    v_cvt_pk_bf16_f32 v48, v48, v49
    v_cvt_pk_bf16_f32 v49, v50, v51
    v_cvt_pk_bf16_f32 v50, v52, v53
    v_cvt_pk_bf16_f32 v51, v54, v55
    v_cvt_pk_bf16_f32 v52, v56, v57
    v_cvt_pk_bf16_f32 v53, v58, v59
    v_cvt_pk_bf16_f32 v54, v60, v61
    v_cvt_pk_bf16_f32 v55, v62, v63
    s_add_u32 s46, s43, 0x400800
    buffer_store_dwordx4 v[48:51], v9, s[20:23], s46 offen sc1
    buffer_store_dwordx4 v[52:55], v9, s[20:23], s46 offen offset:1024 sc1
    v_cvt_pk_bf16_f32 v96, v96, v97
    v_cvt_pk_bf16_f32 v97, v98, v99
    v_cvt_pk_bf16_f32 v98, v100, v101
    v_cvt_pk_bf16_f32 v99, v102, v103
    v_cvt_pk_bf16_f32 v100, v104, v105
    v_cvt_pk_bf16_f32 v101, v106, v107
    v_cvt_pk_bf16_f32 v102, v108, v109
    v_cvt_pk_bf16_f32 v103, v110, v111
    s_add_u32 s46, s43, 0x401800
    buffer_store_dwordx4 v[96:99], v9, s[20:23], s46 offen sc1
    buffer_store_dwordx4 v[100:103], v9, s[20:23], s46 offen offset:1024 sc1
    s_endpgm
K1_END:
    s_endpgm
.globl k2_attn_kernel
.p2align 8
.type k2_attn_kernel,@function
k2_attn_kernel:
    s_cmp_ge_u32 s2, 512
    s_cbranch_scc1 K2_END
    s_load_dwordx2 s[8:9], s[0:1], 80
    v_lshrrev_b32 v1, 6, v0
    v_and_b32 v2, 63, v0
    v_readfirstlane_b32 s24, v1
    s_cmp_ge_u32 s2, 256
    s_cbranch_scc1 K2_P1
    s_and_b32 s28, s2, 7
    s_lshr_b32 s29, s2, 3
    s_lshr_b32 s30, s29, 3
    s_lshl_b32 s25, s30, 1
    s_lshr_b32 s31, s28, 2
    s_add_u32 s25, s25, s31
    s_lshl_b32 s25, s25, 2
    s_and_b32 s28, s28, 3
    s_add_u32 s25, s25, s28
    s_and_b32 s26, s29, 7
    v_lshlrev_b32 v3, 4, v2
    s_lshl_b32 s30, s25, 18
    s_lshl_b32 s31, s24, 12
    s_add_u32 s32, s30, s31
    s_add_u32 s32, s32, 0x400000
    s_lshl_b32 s35, s26, 14
    s_lshl_b32 s36, s24, 11
    s_add_u32 s35, s35, s36
    s_lshl_b32 s36, s25, 17
    s_add_u32 s35, s35, s36
    s_add_u32 s33, s31, 0x10000
    s_sub_u32 s34, s31, 0x4000
    s_cmp_lt_u32 s24, 4
    s_cselect_b32 s33, s33, s34
    s_waitcnt lgkmcnt(0)
    s_mov_b32 s20, s8
    s_mov_b32 s21, s9
    s_mov_b32 s22, 0x4000000
    s_mov_b32 s23, 0x20000
    s_mov_b32 m0, s31
    s_nop 0
    buffer_load_dwordx4 v3, s[20:23], s32 offen offset:0 lds
    buffer_load_dwordx4 v3, s[20:23], s32 offen offset:1024 lds
    buffer_load_dwordx4 v3, s[20:23], s32 offen offset:2048 lds
    buffer_load_dwordx4 v3, s[20:23], s32 offen offset:3072 lds
    buffer_load_dwordx4 v[8:11], v3, s[20:23], s35 offen
    buffer_load_dwordx4 v[12:15], v3, s[20:23], s35 offen offset:1024
    s_add_u32 m0, s31, 0x8000
    s_add_u32 s34, s32, 0x8000
    buffer_load_dwordx4 v3, s[20:23], s34 offen offset:0 lds
    buffer_load_dwordx4 v3, s[20:23], s34 offen offset:1024 lds
    buffer_load_dwordx4 v3, s[20:23], s34 offen offset:2048 lds
    buffer_load_dwordx4 v3, s[20:23], s34 offen offset:3072 lds
    v_lshrrev_b32 v6, 4, v2
    v_lshrrev_b32 v7, 2, v2
    v_xor_b32 v6, v6, v7
    v_and_b32 v6, 1, v6
    v_cmp_eq_u32 vcc, 0, v6
    v_mov_b32 v7, 0x3f803f80
    v_add_u32 v4, 0x10000, v3
    v_cndmask_b32 v84, 0, v7, vcc
    v_cndmask_b32 v85, 0, v7, vcc
    v_cndmask_b32 v86, 0, v7, vcc
    v_cndmask_b32 v87, 0, v7, vcc
    s_waitcnt vmcnt(4)
    s_barrier
    ds_read_b128 v[88:91], v3 offset:0
    ds_read_b128 v[92:95], v3 offset:1024
    ds_read_b128 v[96:99], v3 offset:4096
    ds_read_b128 v[100:103], v3 offset:5120
    s_waitcnt lgkmcnt(2)
    v_mfma_f32_32x32x16_bf16 v[32:47], v[88:91], v[8:11], 0
    v_mfma_f32_32x32x16_bf16 v[32:47], v[92:95], v[12:15], v[32:47]
    s_nop 15
    s_nop 3
    v_max3_f32 v6, v32, v33, v34
    v_max3_f32 v6, v6, v35, v36
    v_max3_f32 v6, v6, v37, v38
    v_max3_f32 v6, v6, v39, v40
    v_max3_f32 v6, v6, v41, v42
    v_max3_f32 v6, v6, v43, v44
    v_max3_f32 v6, v6, v45, v46
    v_max_f32 v6, v6, v47
    v_mov_b32 v7, v6
    s_nop 1
    v_permlane32_swap_b32 v6, v7
    s_nop 1
    v_max_f32 v6, v6, v7
    s_mov_b32 s37, 0xc2c00000
    v_sub_f32 v6, s37, v6
    v_mov_b32 v16, v6
    v_mov_b32 v17, v6
    v_mov_b32 v18, v6
    v_mov_b32 v19, v6
    v_mov_b32 v20, v6
    v_mov_b32 v21, v6
    v_mov_b32 v22, v6
    v_mov_b32 v23, v6
    v_mov_b32 v24, v6
    v_mov_b32 v25, v6
    v_mov_b32 v26, v6
    v_mov_b32 v27, v6
    v_mov_b32 v28, v6
    v_mov_b32 v29, v6
    v_mov_b32 v30, v6
    v_mov_b32 v31, v6
    s_nop 1
    v_mfma_f32_32x32x16_bf16 v[32:47], v[88:91], v[8:11], v[16:31]
    v_mfma_f32_32x32x16_bf16 v[32:47], v[92:95], v[12:15], v[32:47]
    s_nop 8
    s_waitcnt lgkmcnt(0)
    ds_read_b128 v[104:107], v3 offset:2048
    ds_read_b128 v[108:111], v3 offset:3072
    v_exp_f32 v32, v32
    v_exp_f32 v33, v33
    v_exp_f32 v34, v34
    ds_read_b128 v[88:91], v3 offset:8192
    ds_read_b128 v[92:95], v3 offset:9216
    v_exp_f32 v35, v35
    v_cvt_pk_bf16_f32 v32, v32, v33
    v_exp_f32 v36, v36
    v_cvt_pk_bf16_f32 v33, v34, v35
    v_exp_f32 v37, v37
    v_exp_f32 v38, v38
    v_mfma_f32_32x32x16_bf16 v[48:63], v[96:99], v[8:11], v[16:31]
    v_cvt_pk_bf16_f32 v34, v36, v37
    v_exp_f32 v39, v39
    v_exp_f32 v40, v40
    v_cvt_pk_bf16_f32 v35, v38, v39
    v_mfma_f32_32x32x16_bf16 v[48:63], v[100:103], v[12:15], v[48:63]
    v_exp_f32 v41, v41
    v_exp_f32 v42, v42
    v_cvt_pk_bf16_f32 v36, v40, v41
    v_exp_f32 v43, v43
    v_exp_f32 v44, v44
    v_cvt_pk_bf16_f32 v37, v42, v43
    v_exp_f32 v45, v45
    v_exp_f32 v46, v46
    v_exp_f32 v47, v47
    v_cvt_pk_bf16_f32 v38, v44, v45
    v_cvt_pk_bf16_f32 v39, v46, v47
    s_waitcnt lgkmcnt(0)
    v_mfma_f32_32x32x16_bf16 v[64:79], v[104:107], v[32:35], 0
    ds_read_b128 v[112:115], v3 offset:6144
    ds_read_b128 v[116:119], v3 offset:7168
    v_exp_f32 v48, v48
    v_exp_f32 v49, v49
    v_exp_f32 v50, v50
    v_mfma_f32_32x32x16_bf16 v[64:79], v[108:111], v[36:39], v[64:79]
    ds_read_b128 v[96:99], v3 offset:12288
    ds_read_b128 v[100:103], v3 offset:13312
    v_exp_f32 v51, v51
    v_cvt_pk_bf16_f32 v48, v48, v49
    v_exp_f32 v52, v52
    v_cvt_pk_bf16_f32 v49, v50, v51
    v_mfma_f32_16x16x32_bf16 v[80:83], v[84:87], v[32:35], 0
    v_exp_f32 v53, v53
    v_mfma_f32_16x16x32_bf16 v[80:83], v[84:87], v[36:39], v[80:83]
    v_exp_f32 v54, v54
    v_mfma_f32_32x32x16_bf16 v[32:47], v[88:91], v[8:11], v[16:31]
    v_cvt_pk_bf16_f32 v50, v52, v53
    v_exp_f32 v55, v55
    v_exp_f32 v56, v56
    v_cvt_pk_bf16_f32 v51, v54, v55
    v_mfma_f32_32x32x16_bf16 v[32:47], v[92:95], v[12:15], v[32:47]
    v_exp_f32 v57, v57
    v_exp_f32 v58, v58
    v_cvt_pk_bf16_f32 v52, v56, v57
    v_exp_f32 v59, v59
    v_exp_f32 v60, v60
    v_cvt_pk_bf16_f32 v53, v58, v59
    v_exp_f32 v61, v61
    v_exp_f32 v62, v62
    v_exp_f32 v63, v63
    v_cvt_pk_bf16_f32 v54, v60, v61
    v_cvt_pk_bf16_f32 v55, v62, v63
    s_waitcnt lgkmcnt(0)
    v_mfma_f32_32x32x16_bf16 v[64:79], v[112:115], v[48:51], v[64:79]
    ds_read_b128 v[104:107], v3 offset:10240
    ds_read_b128 v[108:111], v3 offset:11264
    v_exp_f32 v32, v32
    v_exp_f32 v33, v33
    v_exp_f32 v34, v34
    v_mfma_f32_32x32x16_bf16 v[64:79], v[116:119], v[52:55], v[64:79]
    ds_read_b128 v[88:91], v3 offset:16384
    ds_read_b128 v[92:95], v3 offset:17408
    v_exp_f32 v35, v35
    v_cvt_pk_bf16_f32 v32, v32, v33
    v_exp_f32 v36, v36
    v_cvt_pk_bf16_f32 v33, v34, v35
    v_mfma_f32_16x16x32_bf16 v[80:83], v[84:87], v[48:51], v[80:83]
    v_exp_f32 v37, v37
    v_mfma_f32_16x16x32_bf16 v[80:83], v[84:87], v[52:55], v[80:83]
    v_exp_f32 v38, v38
    v_mfma_f32_32x32x16_bf16 v[48:63], v[96:99], v[8:11], v[16:31]
    v_cvt_pk_bf16_f32 v34, v36, v37
    v_exp_f32 v39, v39
    v_exp_f32 v40, v40
    v_cvt_pk_bf16_f32 v35, v38, v39
    v_mfma_f32_32x32x16_bf16 v[48:63], v[100:103], v[12:15], v[48:63]
    v_exp_f32 v41, v41
    v_exp_f32 v42, v42
    v_cvt_pk_bf16_f32 v36, v40, v41
    v_exp_f32 v43, v43
    v_exp_f32 v44, v44
    v_cvt_pk_bf16_f32 v37, v42, v43
    v_exp_f32 v45, v45
    v_exp_f32 v46, v46
    v_exp_f32 v47, v47
    v_cvt_pk_bf16_f32 v38, v44, v45
    v_cvt_pk_bf16_f32 v39, v46, v47
    s_waitcnt lgkmcnt(0)
    v_mfma_f32_32x32x16_bf16 v[64:79], v[104:107], v[32:35], v[64:79]
    ds_read_b128 v[112:115], v3 offset:14336
    ds_read_b128 v[116:119], v3 offset:15360
    v_exp_f32 v48, v48
    v_exp_f32 v49, v49
    v_exp_f32 v50, v50
    v_mfma_f32_32x32x16_bf16 v[64:79], v[108:111], v[36:39], v[64:79]
    ds_read_b128 v[96:99], v3 offset:20480
    ds_read_b128 v[100:103], v3 offset:21504
    v_exp_f32 v51, v51
    v_cvt_pk_bf16_f32 v48, v48, v49
    v_exp_f32 v52, v52
    v_cvt_pk_bf16_f32 v49, v50, v51
    v_mfma_f32_16x16x32_bf16 v[80:83], v[84:87], v[32:35], v[80:83]
    v_exp_f32 v53, v53
    v_mfma_f32_16x16x32_bf16 v[80:83], v[84:87], v[36:39], v[80:83]
    v_exp_f32 v54, v54
    v_mfma_f32_32x32x16_bf16 v[32:47], v[88:91], v[8:11], v[16:31]
    v_cvt_pk_bf16_f32 v50, v52, v53
    v_exp_f32 v55, v55
    v_exp_f32 v56, v56
    v_cvt_pk_bf16_f32 v51, v54, v55
    v_mfma_f32_32x32x16_bf16 v[32:47], v[92:95], v[12:15], v[32:47]
    v_exp_f32 v57, v57
    v_exp_f32 v58, v58
    v_cvt_pk_bf16_f32 v52, v56, v57
    v_exp_f32 v59, v59
    v_exp_f32 v60, v60
    v_cvt_pk_bf16_f32 v53, v58, v59
    v_exp_f32 v61, v61
    v_exp_f32 v62, v62
    v_exp_f32 v63, v63
    v_cvt_pk_bf16_f32 v54, v60, v61
    v_cvt_pk_bf16_f32 v55, v62, v63
    s_waitcnt lgkmcnt(0)
    v_mfma_f32_32x32x16_bf16 v[64:79], v[112:115], v[48:51], v[64:79]
    ds_read_b128 v[104:107], v3 offset:18432
    ds_read_b128 v[108:111], v3 offset:19456
    v_exp_f32 v32, v32
    v_exp_f32 v33, v33
    v_exp_f32 v34, v34
    v_mfma_f32_32x32x16_bf16 v[64:79], v[116:119], v[52:55], v[64:79]
    ds_read_b128 v[88:91], v3 offset:24576
    ds_read_b128 v[92:95], v3 offset:25600
    v_exp_f32 v35, v35
    v_cvt_pk_bf16_f32 v32, v32, v33
    v_exp_f32 v36, v36
    v_cvt_pk_bf16_f32 v33, v34, v35
    v_mfma_f32_16x16x32_bf16 v[80:83], v[84:87], v[48:51], v[80:83]
    v_exp_f32 v37, v37
    v_mfma_f32_16x16x32_bf16 v[80:83], v[84:87], v[52:55], v[80:83]
    v_exp_f32 v38, v38
    v_mfma_f32_32x32x16_bf16 v[48:63], v[96:99], v[8:11], v[16:31]
    v_cvt_pk_bf16_f32 v34, v36, v37
    v_exp_f32 v39, v39
    v_exp_f32 v40, v40
    v_cvt_pk_bf16_f32 v35, v38, v39
    v_mfma_f32_32x32x16_bf16 v[48:63], v[100:103], v[12:15], v[48:63]
    v_exp_f32 v41, v41
    v_exp_f32 v42, v42
    v_cvt_pk_bf16_f32 v36, v40, v41
    v_exp_f32 v43, v43
    v_exp_f32 v44, v44
    v_cvt_pk_bf16_f32 v37, v42, v43
    v_exp_f32 v45, v45
    v_exp_f32 v46, v46
    v_exp_f32 v47, v47
    v_cvt_pk_bf16_f32 v38, v44, v45
    v_cvt_pk_bf16_f32 v39, v46, v47
    s_waitcnt lgkmcnt(0)
    v_mfma_f32_32x32x16_bf16 v[64:79], v[104:107], v[32:35], v[64:79]
    ds_read_b128 v[112:115], v3 offset:22528
    ds_read_b128 v[116:119], v3 offset:23552
    v_exp_f32 v48, v48
    v_exp_f32 v49, v49
    v_exp_f32 v50, v50
    v_mfma_f32_32x32x16_bf16 v[64:79], v[108:111], v[36:39], v[64:79]
    ds_read_b128 v[96:99], v3 offset:28672
    ds_read_b128 v[100:103], v3 offset:29696
    v_exp_f32 v51, v51
    v_cvt_pk_bf16_f32 v48, v48, v49
    v_exp_f32 v52, v52
    v_cvt_pk_bf16_f32 v49, v50, v51
    v_mfma_f32_16x16x32_bf16 v[80:83], v[84:87], v[32:35], v[80:83]
    v_exp_f32 v53, v53
    v_mfma_f32_16x16x32_bf16 v[80:83], v[84:87], v[36:39], v[80:83]
    v_exp_f32 v54, v54
    v_mfma_f32_32x32x16_bf16 v[32:47], v[88:91], v[8:11], v[16:31]
    v_cvt_pk_bf16_f32 v50, v52, v53
    v_exp_f32 v55, v55
    v_exp_f32 v56, v56
    v_cvt_pk_bf16_f32 v51, v54, v55
    v_mfma_f32_32x32x16_bf16 v[32:47], v[92:95], v[12:15], v[32:47]
    v_exp_f32 v57, v57
    v_exp_f32 v58, v58
    v_cvt_pk_bf16_f32 v52, v56, v57
    v_exp_f32 v59, v59
    v_exp_f32 v60, v60
    v_cvt_pk_bf16_f32 v53, v58, v59
    v_exp_f32 v61, v61
    v_exp_f32 v62, v62
    v_exp_f32 v63, v63
    v_cvt_pk_bf16_f32 v54, v60, v61
    v_cvt_pk_bf16_f32 v55, v62, v63
    s_waitcnt vmcnt(0) lgkmcnt(0)
    s_barrier
    s_mov_b32 m0, s33
    s_add_u32 s34, s32, 0x10000
    buffer_load_dwordx4 v3, s[20:23], s34 offen offset:0 lds
    buffer_load_dwordx4 v3, s[20:23], s34 offen offset:1024 lds
    buffer_load_dwordx4 v3, s[20:23], s34 offen offset:2048 lds
    buffer_load_dwordx4 v3, s[20:23], s34 offen offset:3072 lds
    v_mfma_f32_32x32x16_bf16 v[64:79], v[112:115], v[48:51], v[64:79]
    ds_read_b128 v[104:107], v3 offset:26624
    ds_read_b128 v[108:111], v3 offset:27648
    v_exp_f32 v32, v32
    v_exp_f32 v33, v33
    v_exp_f32 v34, v34
    v_mfma_f32_32x32x16_bf16 v[64:79], v[116:119], v[52:55], v[64:79]
    ds_read_b128 v[88:91], v3 offset:32768
    ds_read_b128 v[92:95], v3 offset:33792
    v_exp_f32 v35, v35
    v_cvt_pk_bf16_f32 v32, v32, v33
    v_exp_f32 v36, v36
    v_cvt_pk_bf16_f32 v33, v34, v35
    v_mfma_f32_16x16x32_bf16 v[80:83], v[84:87], v[48:51], v[80:83]
    v_exp_f32 v37, v37
    v_mfma_f32_16x16x32_bf16 v[80:83], v[84:87], v[52:55], v[80:83]
    v_exp_f32 v38, v38
    v_mfma_f32_32x32x16_bf16 v[48:63], v[96:99], v[8:11], v[16:31]
    v_cvt_pk_bf16_f32 v34, v36, v37
    v_exp_f32 v39, v39
    v_exp_f32 v40, v40
    v_cvt_pk_bf16_f32 v35, v38, v39
    v_mfma_f32_32x32x16_bf16 v[48:63], v[100:103], v[12:15], v[48:63]
    v_exp_f32 v41, v41
    v_exp_f32 v42, v42
    v_cvt_pk_bf16_f32 v36, v40, v41
    v_exp_f32 v43, v43
    v_exp_f32 v44, v44
    v_cvt_pk_bf16_f32 v37, v42, v43
    v_exp_f32 v45, v45
    v_exp_f32 v46, v46
    v_exp_f32 v47, v47
    v_cvt_pk_bf16_f32 v38, v44, v45
    v_cvt_pk_bf16_f32 v39, v46, v47
    s_waitcnt lgkmcnt(0)
    v_mfma_f32_32x32x16_bf16 v[64:79], v[104:107], v[32:35], v[64:79]
    ds_read_b128 v[112:115], v3 offset:30720
    ds_read_b128 v[116:119], v3 offset:31744
    v_exp_f32 v48, v48
    v_exp_f32 v49, v49
    v_exp_f32 v50, v50
    v_mfma_f32_32x32x16_bf16 v[64:79], v[108:111], v[36:39], v[64:79]
    ds_read_b128 v[96:99], v3 offset:36864
    ds_read_b128 v[100:103], v3 offset:37888
    v_exp_f32 v51, v51
    v_cvt_pk_bf16_f32 v48, v48, v49
    v_exp_f32 v52, v52
    v_cvt_pk_bf16_f32 v49, v50, v51
    v_mfma_f32_16x16x32_bf16 v[80:83], v[84:87], v[32:35], v[80:83]
    v_exp_f32 v53, v53
    v_mfma_f32_16x16x32_bf16 v[80:83], v[84:87], v[36:39], v[80:83]
    v_exp_f32 v54, v54
    v_mfma_f32_32x32x16_bf16 v[32:47], v[88:91], v[8:11], v[16:31]
    v_cvt_pk_bf16_f32 v50, v52, v53
    v_exp_f32 v55, v55
    v_exp_f32 v56, v56
    v_cvt_pk_bf16_f32 v51, v54, v55
    v_mfma_f32_32x32x16_bf16 v[32:47], v[92:95], v[12:15], v[32:47]
    v_exp_f32 v57, v57
    v_exp_f32 v58, v58
    v_cvt_pk_bf16_f32 v52, v56, v57
    v_exp_f32 v59, v59
    v_exp_f32 v60, v60
    v_cvt_pk_bf16_f32 v53, v58, v59
    v_exp_f32 v61, v61
    v_exp_f32 v62, v62
    v_exp_f32 v63, v63
    v_cvt_pk_bf16_f32 v54, v60, v61
    v_cvt_pk_bf16_f32 v55, v62, v63
    s_waitcnt lgkmcnt(0)
    v_mfma_f32_32x32x16_bf16 v[64:79], v[112:115], v[48:51], v[64:79]
    ds_read_b128 v[104:107], v3 offset:34816
    ds_read_b128 v[108:111], v3 offset:35840
    v_exp_f32 v32, v32
    v_exp_f32 v33, v33
    v_exp_f32 v34, v34
    v_mfma_f32_32x32x16_bf16 v[64:79], v[116:119], v[52:55], v[64:79]
    ds_read_b128 v[88:91], v3 offset:40960
    ds_read_b128 v[92:95], v3 offset:41984
    v_exp_f32 v35, v35
    v_cvt_pk_bf16_f32 v32, v32, v33
    v_exp_f32 v36, v36
    v_cvt_pk_bf16_f32 v33, v34, v35
    v_mfma_f32_16x16x32_bf16 v[80:83], v[84:87], v[48:51], v[80:83]
    v_exp_f32 v37, v37
    v_mfma_f32_16x16x32_bf16 v[80:83], v[84:87], v[52:55], v[80:83]
    v_exp_f32 v38, v38
    v_mfma_f32_32x32x16_bf16 v[48:63], v[96:99], v[8:11], v[16:31]
    v_cvt_pk_bf16_f32 v34, v36, v37
    v_exp_f32 v39, v39
    v_exp_f32 v40, v40
    v_cvt_pk_bf16_f32 v35, v38, v39
    v_mfma_f32_32x32x16_bf16 v[48:63], v[100:103], v[12:15], v[48:63]
    v_exp_f32 v41, v41
    v_exp_f32 v42, v42
    v_cvt_pk_bf16_f32 v36, v40, v41
    v_exp_f32 v43, v43
    v_exp_f32 v44, v44
    v_cvt_pk_bf16_f32 v37, v42, v43
    v_exp_f32 v45, v45
    v_exp_f32 v46, v46
    v_exp_f32 v47, v47
    v_cvt_pk_bf16_f32 v38, v44, v45
    v_cvt_pk_bf16_f32 v39, v46, v47
    s_waitcnt lgkmcnt(0)
    v_mfma_f32_32x32x16_bf16 v[64:79], v[104:107], v[32:35], v[64:79]
    ds_read_b128 v[112:115], v3 offset:38912
    ds_read_b128 v[116:119], v3 offset:39936
    v_exp_f32 v48, v48
    v_exp_f32 v49, v49
    v_exp_f32 v50, v50
    v_mfma_f32_32x32x16_bf16 v[64:79], v[108:111], v[36:39], v[64:79]
    ds_read_b128 v[96:99], v3 offset:45056
    ds_read_b128 v[100:103], v3 offset:46080
    v_exp_f32 v51, v51
    v_cvt_pk_bf16_f32 v48, v48, v49
    v_exp_f32 v52, v52
    v_cvt_pk_bf16_f32 v49, v50, v51
    v_mfma_f32_16x16x32_bf16 v[80:83], v[84:87], v[32:35], v[80:83]
    v_exp_f32 v53, v53
    v_mfma_f32_16x16x32_bf16 v[80:83], v[84:87], v[36:39], v[80:83]
    v_exp_f32 v54, v54
    v_mfma_f32_32x32x16_bf16 v[32:47], v[88:91], v[8:11], v[16:31]
    v_cvt_pk_bf16_f32 v50, v52, v53
    v_exp_f32 v55, v55
    v_exp_f32 v56, v56
    v_cvt_pk_bf16_f32 v51, v54, v55
    v_mfma_f32_32x32x16_bf16 v[32:47], v[92:95], v[12:15], v[32:47]
    v_exp_f32 v57, v57
    v_exp_f32 v58, v58
    v_cvt_pk_bf16_f32 v52, v56, v57
    v_exp_f32 v59, v59
    v_exp_f32 v60, v60
    v_cvt_pk_bf16_f32 v53, v58, v59
    v_exp_f32 v61, v61
    v_exp_f32 v62, v62
    v_exp_f32 v63, v63
    v_cvt_pk_bf16_f32 v54, v60, v61
    v_cvt_pk_bf16_f32 v55, v62, v63
    s_waitcnt lgkmcnt(0)
    v_mfma_f32_32x32x16_bf16 v[64:79], v[112:115], v[48:51], v[64:79]
    ds_read_b128 v[104:107], v3 offset:43008
    ds_read_b128 v[108:111], v3 offset:44032
    v_exp_f32 v32, v32
    v_exp_f32 v33, v33
    v_exp_f32 v34, v34
    v_mfma_f32_32x32x16_bf16 v[64:79], v[116:119], v[52:55], v[64:79]
    ds_read_b128 v[88:91], v3 offset:49152
    ds_read_b128 v[92:95], v3 offset:50176
    v_exp_f32 v35, v35
    v_cvt_pk_bf16_f32 v32, v32, v33
    v_exp_f32 v36, v36
    v_cvt_pk_bf16_f32 v33, v34, v35
    v_mfma_f32_16x16x32_bf16 v[80:83], v[84:87], v[48:51], v[80:83]
    v_exp_f32 v37, v37
    v_mfma_f32_16x16x32_bf16 v[80:83], v[84:87], v[52:55], v[80:83]
    v_exp_f32 v38, v38
    v_mfma_f32_32x32x16_bf16 v[48:63], v[96:99], v[8:11], v[16:31]
    v_cvt_pk_bf16_f32 v34, v36, v37
    v_exp_f32 v39, v39
    v_exp_f32 v40, v40
    v_cvt_pk_bf16_f32 v35, v38, v39
    v_mfma_f32_32x32x16_bf16 v[48:63], v[100:103], v[12:15], v[48:63]
    v_exp_f32 v41, v41
    v_exp_f32 v42, v42
    v_cvt_pk_bf16_f32 v36, v40, v41
    v_exp_f32 v43, v43
    v_exp_f32 v44, v44
    v_cvt_pk_bf16_f32 v37, v42, v43
    v_exp_f32 v45, v45
    v_exp_f32 v46, v46
    v_exp_f32 v47, v47
    v_cvt_pk_bf16_f32 v38, v44, v45
    v_cvt_pk_bf16_f32 v39, v46, v47
    s_waitcnt lgkmcnt(0)
    v_mfma_f32_32x32x16_bf16 v[64:79], v[104:107], v[32:35], v[64:79]
    ds_read_b128 v[112:115], v3 offset:47104
    ds_read_b128 v[116:119], v3 offset:48128
    v_exp_f32 v48, v48
    v_exp_f32 v49, v49
    v_exp_f32 v50, v50
    v_mfma_f32_32x32x16_bf16 v[64:79], v[108:111], v[36:39], v[64:79]
    ds_read_b128 v[96:99], v3 offset:53248
    ds_read_b128 v[100:103], v3 offset:54272
    v_exp_f32 v51, v51
    v_cvt_pk_bf16_f32 v48, v48, v49
    v_exp_f32 v52, v52
    v_cvt_pk_bf16_f32 v49, v50, v51
    v_mfma_f32_16x16x32_bf16 v[80:83], v[84:87], v[32:35], v[80:83]
    v_exp_f32 v53, v53
    v_mfma_f32_16x16x32_bf16 v[80:83], v[84:87], v[36:39], v[80:83]
    v_exp_f32 v54, v54
    v_mfma_f32_32x32x16_bf16 v[32:47], v[88:91], v[8:11], v[16:31]
    v_cvt_pk_bf16_f32 v50, v52, v53
    v_exp_f32 v55, v55
    v_exp_f32 v56, v56
    v_cvt_pk_bf16_f32 v51, v54, v55
    v_mfma_f32_32x32x16_bf16 v[32:47], v[92:95], v[12:15], v[32:47]
    v_exp_f32 v57, v57
    v_exp_f32 v58, v58
    v_cvt_pk_bf16_f32 v52, v56, v57
    v_exp_f32 v59, v59
    v_exp_f32 v60, v60
    v_cvt_pk_bf16_f32 v53, v58, v59
    v_exp_f32 v61, v61
    v_exp_f32 v62, v62
    v_exp_f32 v63, v63
    v_cvt_pk_bf16_f32 v54, v60, v61
    v_cvt_pk_bf16_f32 v55, v62, v63
    s_waitcnt lgkmcnt(0)
    v_mfma_f32_32x32x16_bf16 v[64:79], v[112:115], v[48:51], v[64:79]
    ds_read_b128 v[104:107], v3 offset:51200
    ds_read_b128 v[108:111], v3 offset:52224
    v_exp_f32 v32, v32
    v_exp_f32 v33, v33
    v_exp_f32 v34, v34
    v_mfma_f32_32x32x16_bf16 v[64:79], v[116:119], v[52:55], v[64:79]
    ds_read_b128 v[88:91], v3 offset:57344
    ds_read_b128 v[92:95], v3 offset:58368
    v_exp_f32 v35, v35
    v_cvt_pk_bf16_f32 v32, v32, v33
    v_exp_f32 v36, v36
    v_cvt_pk_bf16_f32 v33, v34, v35
    v_mfma_f32_16x16x32_bf16 v[80:83], v[84:87], v[48:51], v[80:83]
    v_exp_f32 v37, v37
    v_mfma_f32_16x16x32_bf16 v[80:83], v[84:87], v[52:55], v[80:83]
    v_exp_f32 v38, v38
    v_mfma_f32_32x32x16_bf16 v[48:63], v[96:99], v[8:11], v[16:31]
    v_cvt_pk_bf16_f32 v34, v36, v37
    v_exp_f32 v39, v39
    v_exp_f32 v40, v40
    v_cvt_pk_bf16_f32 v35, v38, v39
    v_mfma_f32_32x32x16_bf16 v[48:63], v[100:103], v[12:15], v[48:63]
    v_exp_f32 v41, v41
    v_exp_f32 v42, v42
    v_cvt_pk_bf16_f32 v36, v40, v41
    v_exp_f32 v43, v43
    v_exp_f32 v44, v44
    v_cvt_pk_bf16_f32 v37, v42, v43
    v_exp_f32 v45, v45
    v_exp_f32 v46, v46
    v_exp_f32 v47, v47
    v_cvt_pk_bf16_f32 v38, v44, v45
    v_cvt_pk_bf16_f32 v39, v46, v47
    s_waitcnt lgkmcnt(0)
    v_mfma_f32_32x32x16_bf16 v[64:79], v[104:107], v[32:35], v[64:79]
    ds_read_b128 v[112:115], v3 offset:55296
    ds_read_b128 v[116:119], v3 offset:56320
    v_exp_f32 v48, v48
    v_exp_f32 v49, v49
    v_exp_f32 v50, v50
    v_mfma_f32_32x32x16_bf16 v[64:79], v[108:111], v[36:39], v[64:79]
    ds_read_b128 v[96:99], v3 offset:61440
    ds_read_b128 v[100:103], v3 offset:62464
    v_exp_f32 v51, v51
    v_cvt_pk_bf16_f32 v48, v48, v49
    v_exp_f32 v52, v52
    v_cvt_pk_bf16_f32 v49, v50, v51
    v_mfma_f32_16x16x32_bf16 v[80:83], v[84:87], v[32:35], v[80:83]
    v_exp_f32 v53, v53
    v_mfma_f32_16x16x32_bf16 v[80:83], v[84:87], v[36:39], v[80:83]
    v_exp_f32 v54, v54
    v_mfma_f32_32x32x16_bf16 v[32:47], v[88:91], v[8:11], v[16:31]
    v_cvt_pk_bf16_f32 v50, v52, v53
    v_exp_f32 v55, v55
    v_exp_f32 v56, v56
    v_cvt_pk_bf16_f32 v51, v54, v55
    v_mfma_f32_32x32x16_bf16 v[32:47], v[92:95], v[12:15], v[32:47]
    v_exp_f32 v57, v57
    v_exp_f32 v58, v58
    v_cvt_pk_bf16_f32 v52, v56, v57
    v_exp_f32 v59, v59
    v_exp_f32 v60, v60
    v_cvt_pk_bf16_f32 v53, v58, v59
    v_exp_f32 v61, v61
    v_exp_f32 v62, v62
    v_exp_f32 v63, v63
    v_cvt_pk_bf16_f32 v54, v60, v61
    v_cvt_pk_bf16_f32 v55, v62, v63
    s_waitcnt vmcnt(0) lgkmcnt(0)
    s_barrier
    s_add_u32 m0, s31, 0x4000
    s_add_u32 s34, s32, 0x18000
    buffer_load_dwordx4 v3, s[20:23], s34 offen offset:0 lds
    buffer_load_dwordx4 v3, s[20:23], s34 offen offset:1024 lds
    buffer_load_dwordx4 v3, s[20:23], s34 offen offset:2048 lds
    buffer_load_dwordx4 v3, s[20:23], s34 offen offset:3072 lds
    v_mfma_f32_32x32x16_bf16 v[64:79], v[112:115], v[48:51], v[64:79]
    ds_read_b128 v[104:107], v3 offset:59392
    ds_read_b128 v[108:111], v3 offset:60416
    v_exp_f32 v32, v32
    v_exp_f32 v33, v33
    v_exp_f32 v34, v34
    v_mfma_f32_32x32x16_bf16 v[64:79], v[116:119], v[52:55], v[64:79]
    ds_read_b128 v[88:91], v4 offset:0
    ds_read_b128 v[92:95], v4 offset:1024
    v_exp_f32 v35, v35
    v_cvt_pk_bf16_f32 v32, v32, v33
    v_exp_f32 v36, v36
    v_cvt_pk_bf16_f32 v33, v34, v35
    v_mfma_f32_16x16x32_bf16 v[80:83], v[84:87], v[48:51], v[80:83]
    v_exp_f32 v37, v37
    v_mfma_f32_16x16x32_bf16 v[80:83], v[84:87], v[52:55], v[80:83]
    v_exp_f32 v38, v38
    v_mfma_f32_32x32x16_bf16 v[48:63], v[96:99], v[8:11], v[16:31]
    v_cvt_pk_bf16_f32 v34, v36, v37
    v_exp_f32 v39, v39
    v_exp_f32 v40, v40
    v_cvt_pk_bf16_f32 v35, v38, v39
    v_mfma_f32_32x32x16_bf16 v[48:63], v[100:103], v[12:15], v[48:63]
    v_exp_f32 v41, v41
    v_exp_f32 v42, v42
    v_cvt_pk_bf16_f32 v36, v40, v41
    v_exp_f32 v43, v43
    v_exp_f32 v44, v44
    v_cvt_pk_bf16_f32 v37, v42, v43
    v_exp_f32 v45, v45
    v_exp_f32 v46, v46
    v_exp_f32 v47, v47
    v_cvt_pk_bf16_f32 v38, v44, v45
    v_cvt_pk_bf16_f32 v39, v46, v47
    s_waitcnt lgkmcnt(0)
    v_mfma_f32_32x32x16_bf16 v[64:79], v[104:107], v[32:35], v[64:79]
    ds_read_b128 v[112:115], v3 offset:63488
    ds_read_b128 v[116:119], v3 offset:64512
    v_exp_f32 v48, v48
    v_exp_f32 v49, v49
    v_exp_f32 v50, v50
    v_mfma_f32_32x32x16_bf16 v[64:79], v[108:111], v[36:39], v[64:79]
    ds_read_b128 v[96:99], v4 offset:4096
    ds_read_b128 v[100:103], v4 offset:5120
    v_exp_f32 v51, v51
    v_cvt_pk_bf16_f32 v48, v48, v49
    v_exp_f32 v52, v52
    v_cvt_pk_bf16_f32 v49, v50, v51
    v_mfma_f32_16x16x32_bf16 v[80:83], v[84:87], v[32:35], v[80:83]
    v_exp_f32 v53, v53
    v_mfma_f32_16x16x32_bf16 v[80:83], v[84:87], v[36:39], v[80:83]
    v_exp_f32 v54, v54
    v_mfma_f32_32x32x16_bf16 v[32:47], v[88:91], v[8:11], v[16:31]
    v_cvt_pk_bf16_f32 v50, v52, v53
    v_exp_f32 v55, v55
    v_exp_f32 v56, v56
    v_cvt_pk_bf16_f32 v51, v54, v55
    v_mfma_f32_32x32x16_bf16 v[32:47], v[92:95], v[12:15], v[32:47]
    v_exp_f32 v57, v57
    v_exp_f32 v58, v58
    v_cvt_pk_bf16_f32 v52, v56, v57
    v_exp_f32 v59, v59
    v_exp_f32 v60, v60
    v_cvt_pk_bf16_f32 v53, v58, v59
    v_exp_f32 v61, v61
    v_exp_f32 v62, v62
    v_exp_f32 v63, v63
    v_cvt_pk_bf16_f32 v54, v60, v61
    v_cvt_pk_bf16_f32 v55, v62, v63
    s_waitcnt lgkmcnt(0)
    v_mfma_f32_32x32x16_bf16 v[64:79], v[112:115], v[48:51], v[64:79]
    ds_read_b128 v[104:107], v4 offset:2048
    ds_read_b128 v[108:111], v4 offset:3072
    v_exp_f32 v32, v32
    v_exp_f32 v33, v33
    v_exp_f32 v34, v34
    v_mfma_f32_32x32x16_bf16 v[64:79], v[116:119], v[52:55], v[64:79]
    ds_read_b128 v[88:91], v4 offset:8192
    ds_read_b128 v[92:95], v4 offset:9216
    v_exp_f32 v35, v35
    v_cvt_pk_bf16_f32 v32, v32, v33
    v_exp_f32 v36, v36
    v_cvt_pk_bf16_f32 v33, v34, v35
    v_mfma_f32_16x16x32_bf16 v[80:83], v[84:87], v[48:51], v[80:83]
    v_exp_f32 v37, v37
    v_mfma_f32_16x16x32_bf16 v[80:83], v[84:87], v[52:55], v[80:83]
    v_exp_f32 v38, v38
    v_mfma_f32_32x32x16_bf16 v[48:63], v[96:99], v[8:11], v[16:31]
    v_cvt_pk_bf16_f32 v34, v36, v37
    v_exp_f32 v39, v39
    v_exp_f32 v40, v40
    v_cvt_pk_bf16_f32 v35, v38, v39
    v_mfma_f32_32x32x16_bf16 v[48:63], v[100:103], v[12:15], v[48:63]
    v_exp_f32 v41, v41
    v_exp_f32 v42, v42
    v_cvt_pk_bf16_f32 v36, v40, v41
    v_exp_f32 v43, v43
    v_exp_f32 v44, v44
    v_cvt_pk_bf16_f32 v37, v42, v43
    v_exp_f32 v45, v45
    v_exp_f32 v46, v46
    v_exp_f32 v47, v47
    v_cvt_pk_bf16_f32 v38, v44, v45
    v_cvt_pk_bf16_f32 v39, v46, v47
    s_waitcnt lgkmcnt(0)
    v_mfma_f32_32x32x16_bf16 v[64:79], v[104:107], v[32:35], v[64:79]
    ds_read_b128 v[112:115], v4 offset:6144
    ds_read_b128 v[116:119], v4 offset:7168
    v_exp_f32 v48, v48
    v_exp_f32 v49, v49
    v_exp_f32 v50, v50
    v_mfma_f32_32x32x16_bf16 v[64:79], v[108:111], v[36:39], v[64:79]
    ds_read_b128 v[96:99], v4 offset:12288
    ds_read_b128 v[100:103], v4 offset:13312
    v_exp_f32 v51, v51
    v_cvt_pk_bf16_f32 v48, v48, v49
    v_exp_f32 v52, v52
    v_cvt_pk_bf16_f32 v49, v50, v51
    v_mfma_f32_16x16x32_bf16 v[80:83], v[84:87], v[32:35], v[80:83]
    v_exp_f32 v53, v53
    v_mfma_f32_16x16x32_bf16 v[80:83], v[84:87], v[36:39], v[80:83]
    v_exp_f32 v54, v54
    v_mfma_f32_32x32x16_bf16 v[32:47], v[88:91], v[8:11], v[16:31]
    v_cvt_pk_bf16_f32 v50, v52, v53
    v_exp_f32 v55, v55
    v_exp_f32 v56, v56
    v_cvt_pk_bf16_f32 v51, v54, v55
    v_mfma_f32_32x32x16_bf16 v[32:47], v[92:95], v[12:15], v[32:47]
    v_exp_f32 v57, v57
    v_exp_f32 v58, v58
    v_cvt_pk_bf16_f32 v52, v56, v57
    v_exp_f32 v59, v59
    v_exp_f32 v60, v60
    v_cvt_pk_bf16_f32 v53, v58, v59
    v_exp_f32 v61, v61
    v_exp_f32 v62, v62
    v_exp_f32 v63, v63
    v_cvt_pk_bf16_f32 v54, v60, v61
    v_cvt_pk_bf16_f32 v55, v62, v63
    s_waitcnt lgkmcnt(0)
    v_mfma_f32_32x32x16_bf16 v[64:79], v[112:115], v[48:51], v[64:79]
    ds_read_b128 v[104:107], v4 offset:10240
    ds_read_b128 v[108:111], v4 offset:11264
    v_exp_f32 v32, v32
    v_exp_f32 v33, v33
    v_exp_f32 v34, v34
    v_mfma_f32_32x32x16_bf16 v[64:79], v[116:119], v[52:55], v[64:79]
    ds_read_b128 v[88:91], v3 offset:0
    ds_read_b128 v[92:95], v3 offset:1024
    v_exp_f32 v35, v35
    v_cvt_pk_bf16_f32 v32, v32, v33
    v_exp_f32 v36, v36
    v_cvt_pk_bf16_f32 v33, v34, v35
    v_mfma_f32_16x16x32_bf16 v[80:83], v[84:87], v[48:51], v[80:83]
    v_exp_f32 v37, v37
    v_mfma_f32_16x16x32_bf16 v[80:83], v[84:87], v[52:55], v[80:83]
    v_exp_f32 v38, v38
    v_mfma_f32_32x32x16_bf16 v[48:63], v[96:99], v[8:11], v[16:31]
    v_cvt_pk_bf16_f32 v34, v36, v37
    v_exp_f32 v39, v39
    v_exp_f32 v40, v40
    v_cvt_pk_bf16_f32 v35, v38, v39
    v_mfma_f32_32x32x16_bf16 v[48:63], v[100:103], v[12:15], v[48:63]
    v_exp_f32 v41, v41
    v_exp_f32 v42, v42
    v_cvt_pk_bf16_f32 v36, v40, v41
    v_exp_f32 v43, v43
    v_exp_f32 v44, v44
    v_cvt_pk_bf16_f32 v37, v42, v43
    v_exp_f32 v45, v45
    v_exp_f32 v46, v46
    v_exp_f32 v47, v47
    v_cvt_pk_bf16_f32 v38, v44, v45
    v_cvt_pk_bf16_f32 v39, v46, v47
    s_waitcnt lgkmcnt(0)
    v_mfma_f32_32x32x16_bf16 v[64:79], v[104:107], v[32:35], v[64:79]
    ds_read_b128 v[112:115], v4 offset:14336
    ds_read_b128 v[116:119], v4 offset:15360
    v_exp_f32 v48, v48
    v_exp_f32 v49, v49
    v_exp_f32 v50, v50
    v_mfma_f32_32x32x16_bf16 v[64:79], v[108:111], v[36:39], v[64:79]
    ds_read_b128 v[96:99], v3 offset:4096
    ds_read_b128 v[100:103], v3 offset:5120
    v_exp_f32 v51, v51
    v_cvt_pk_bf16_f32 v48, v48, v49
    v_exp_f32 v52, v52
    v_cvt_pk_bf16_f32 v49, v50, v51
    v_mfma_f32_16x16x32_bf16 v[80:83], v[84:87], v[32:35], v[80:83]
    v_exp_f32 v53, v53
    v_mfma_f32_16x16x32_bf16 v[80:83], v[84:87], v[36:39], v[80:83]
    v_exp_f32 v54, v54
    v_mfma_f32_32x32x16_bf16 v[32:47], v[88:91], v[8:11], v[16:31]
    v_cvt_pk_bf16_f32 v50, v52, v53
    v_exp_f32 v55, v55
    v_exp_f32 v56, v56
    v_cvt_pk_bf16_f32 v51, v54, v55
    v_mfma_f32_32x32x16_bf16 v[32:47], v[92:95], v[12:15], v[32:47]
    v_exp_f32 v57, v57
    v_exp_f32 v58, v58
    v_cvt_pk_bf16_f32 v52, v56, v57
    v_exp_f32 v59, v59
    v_exp_f32 v60, v60
    v_cvt_pk_bf16_f32 v53, v58, v59
    v_exp_f32 v61, v61
    v_exp_f32 v62, v62
    v_exp_f32 v63, v63
    v_cvt_pk_bf16_f32 v54, v60, v61
    v_cvt_pk_bf16_f32 v55, v62, v63
    s_waitcnt lgkmcnt(0)
    v_mfma_f32_32x32x16_bf16 v[64:79], v[112:115], v[48:51], v[64:79]
    ds_read_b128 v[104:107], v3 offset:2048
    ds_read_b128 v[108:111], v3 offset:3072
    v_exp_f32 v32, v32
    v_exp_f32 v33, v33
    v_exp_f32 v34, v34
    v_mfma_f32_32x32x16_bf16 v[64:79], v[116:119], v[52:55], v[64:79]
    ds_read_b128 v[88:91], v3 offset:8192
    ds_read_b128 v[92:95], v3 offset:9216
    v_exp_f32 v35, v35
    v_cvt_pk_bf16_f32 v32, v32, v33
    v_exp_f32 v36, v36
    v_cvt_pk_bf16_f32 v33, v34, v35
    v_mfma_f32_16x16x32_bf16 v[80:83], v[84:87], v[48:51], v[80:83]
    v_exp_f32 v37, v37
    v_mfma_f32_16x16x32_bf16 v[80:83], v[84:87], v[52:55], v[80:83]
    v_exp_f32 v38, v38
    v_mfma_f32_32x32x16_bf16 v[48:63], v[96:99], v[8:11], v[16:31]
    v_cvt_pk_bf16_f32 v34, v36, v37
    v_exp_f32 v39, v39
    v_exp_f32 v40, v40
    v_cvt_pk_bf16_f32 v35, v38, v39
    v_mfma_f32_32x32x16_bf16 v[48:63], v[100:103], v[12:15], v[48:63]
    v_exp_f32 v41, v41
    v_exp_f32 v42, v42
    v_cvt_pk_bf16_f32 v36, v40, v41
    v_exp_f32 v43, v43
    v_exp_f32 v44, v44
    v_cvt_pk_bf16_f32 v37, v42, v43
    v_exp_f32 v45, v45
    v_exp_f32 v46, v46
    v_exp_f32 v47, v47
    v_cvt_pk_bf16_f32 v38, v44, v45
    v_cvt_pk_bf16_f32 v39, v46, v47
    s_waitcnt lgkmcnt(0)
    v_mfma_f32_32x32x16_bf16 v[64:79], v[104:107], v[32:35], v[64:79]
    ds_read_b128 v[112:115], v3 offset:6144
    ds_read_b128 v[116:119], v3 offset:7168
    v_exp_f32 v48, v48
    v_exp_f32 v49, v49
    v_exp_f32 v50, v50
    v_mfma_f32_32x32x16_bf16 v[64:79], v[108:111], v[36:39], v[64:79]
    ds_read_b128 v[96:99], v3 offset:12288
    ds_read_b128 v[100:103], v3 offset:13312
    v_exp_f32 v51, v51
    v_cvt_pk_bf16_f32 v48, v48, v49
    v_exp_f32 v52, v52
    v_cvt_pk_bf16_f32 v49, v50, v51
    v_mfma_f32_16x16x32_bf16 v[80:83], v[84:87], v[32:35], v[80:83]
    v_exp_f32 v53, v53
    v_mfma_f32_16x16x32_bf16 v[80:83], v[84:87], v[36:39], v[80:83]
    v_exp_f32 v54, v54
    v_mfma_f32_32x32x16_bf16 v[32:47], v[88:91], v[8:11], v[16:31]
    v_cvt_pk_bf16_f32 v50, v52, v53
    v_exp_f32 v55, v55
    v_exp_f32 v56, v56
    v_cvt_pk_bf16_f32 v51, v54, v55
    v_mfma_f32_32x32x16_bf16 v[32:47], v[92:95], v[12:15], v[32:47]
    v_exp_f32 v57, v57
    v_exp_f32 v58, v58
    v_cvt_pk_bf16_f32 v52, v56, v57
    v_exp_f32 v59, v59
    v_exp_f32 v60, v60
    v_cvt_pk_bf16_f32 v53, v58, v59
    v_exp_f32 v61, v61
    v_exp_f32 v62, v62
    v_exp_f32 v63, v63
    v_cvt_pk_bf16_f32 v54, v60, v61
    v_cvt_pk_bf16_f32 v55, v62, v63
    s_waitcnt vmcnt(0) lgkmcnt(0)
    s_barrier
    s_add_u32 m0, s31, 0xc000
    s_add_u32 s34, s32, 0x20000
    buffer_load_dwordx4 v3, s[20:23], s34 offen offset:0 lds
    buffer_load_dwordx4 v3, s[20:23], s34 offen offset:1024 lds
    buffer_load_dwordx4 v3, s[20:23], s34 offen offset:2048 lds
    buffer_load_dwordx4 v3, s[20:23], s34 offen offset:3072 lds
    v_mfma_f32_32x32x16_bf16 v[64:79], v[112:115], v[48:51], v[64:79]
    ds_read_b128 v[104:107], v3 offset:10240
    ds_read_b128 v[108:111], v3 offset:11264
    v_exp_f32 v32, v32
    v_exp_f32 v33, v33
    v_exp_f32 v34, v34
    v_mfma_f32_32x32x16_bf16 v[64:79], v[116:119], v[52:55], v[64:79]
    ds_read_b128 v[88:91], v3 offset:16384
    ds_read_b128 v[92:95], v3 offset:17408
    v_exp_f32 v35, v35
    v_cvt_pk_bf16_f32 v32, v32, v33
    v_exp_f32 v36, v36
    v_cvt_pk_bf16_f32 v33, v34, v35
    v_mfma_f32_16x16x32_bf16 v[80:83], v[84:87], v[48:51], v[80:83]
    v_exp_f32 v37, v37
    v_mfma_f32_16x16x32_bf16 v[80:83], v[84:87], v[52:55], v[80:83]
    v_exp_f32 v38, v38
    v_mfma_f32_32x32x16_bf16 v[48:63], v[96:99], v[8:11], v[16:31]
    v_cvt_pk_bf16_f32 v34, v36, v37
    v_exp_f32 v39, v39
    v_exp_f32 v40, v40
    v_cvt_pk_bf16_f32 v35, v38, v39
    v_mfma_f32_32x32x16_bf16 v[48:63], v[100:103], v[12:15], v[48:63]
    v_exp_f32 v41, v41
    v_exp_f32 v42, v42
    v_cvt_pk_bf16_f32 v36, v40, v41
    v_exp_f32 v43, v43
    v_exp_f32 v44, v44
    v_cvt_pk_bf16_f32 v37, v42, v43
    v_exp_f32 v45, v45
    v_exp_f32 v46, v46
    v_exp_f32 v47, v47
    v_cvt_pk_bf16_f32 v38, v44, v45
    v_cvt_pk_bf16_f32 v39, v46, v47
    s_waitcnt lgkmcnt(0)
    v_mfma_f32_32x32x16_bf16 v[64:79], v[104:107], v[32:35], v[64:79]
    ds_read_b128 v[112:115], v3 offset:14336
    ds_read_b128 v[116:119], v3 offset:15360
    v_exp_f32 v48, v48
    v_exp_f32 v49, v49
    v_exp_f32 v50, v50
    v_mfma_f32_32x32x16_bf16 v[64:79], v[108:111], v[36:39], v[64:79]
    ds_read_b128 v[96:99], v3 offset:20480
    ds_read_b128 v[100:103], v3 offset:21504
    v_exp_f32 v51, v51
    v_cvt_pk_bf16_f32 v48, v48, v49
    v_exp_f32 v52, v52
    v_cvt_pk_bf16_f32 v49, v50, v51
    v_mfma_f32_16x16x32_bf16 v[80:83], v[84:87], v[32:35], v[80:83]
    v_exp_f32 v53, v53
    v_mfma_f32_16x16x32_bf16 v[80:83], v[84:87], v[36:39], v[80:83]
    v_exp_f32 v54, v54
    v_mfma_f32_32x32x16_bf16 v[32:47], v[88:91], v[8:11], v[16:31]
    v_cvt_pk_bf16_f32 v50, v52, v53
    v_exp_f32 v55, v55
    v_exp_f32 v56, v56
    v_cvt_pk_bf16_f32 v51, v54, v55
    v_mfma_f32_32x32x16_bf16 v[32:47], v[92:95], v[12:15], v[32:47]
    v_exp_f32 v57, v57
    v_exp_f32 v58, v58
    v_cvt_pk_bf16_f32 v52, v56, v57
    v_exp_f32 v59, v59
    v_exp_f32 v60, v60
    v_cvt_pk_bf16_f32 v53, v58, v59
    v_exp_f32 v61, v61
    v_exp_f32 v62, v62
    v_exp_f32 v63, v63
    v_cvt_pk_bf16_f32 v54, v60, v61
    v_cvt_pk_bf16_f32 v55, v62, v63
    s_waitcnt lgkmcnt(0)
    v_mfma_f32_32x32x16_bf16 v[64:79], v[112:115], v[48:51], v[64:79]
    ds_read_b128 v[104:107], v3 offset:18432
    ds_read_b128 v[108:111], v3 offset:19456
    v_exp_f32 v32, v32
    v_exp_f32 v33, v33
    v_exp_f32 v34, v34
    v_mfma_f32_32x32x16_bf16 v[64:79], v[116:119], v[52:55], v[64:79]
    ds_read_b128 v[88:91], v3 offset:24576
    ds_read_b128 v[92:95], v3 offset:25600
    v_exp_f32 v35, v35
    v_cvt_pk_bf16_f32 v32, v32, v33
    v_exp_f32 v36, v36
    v_cvt_pk_bf16_f32 v33, v34, v35
    v_mfma_f32_16x16x32_bf16 v[80:83], v[84:87], v[48:51], v[80:83]
    v_exp_f32 v37, v37
    v_mfma_f32_16x16x32_bf16 v[80:83], v[84:87], v[52:55], v[80:83]
    v_exp_f32 v38, v38
    v_mfma_f32_32x32x16_bf16 v[48:63], v[96:99], v[8:11], v[16:31]
    v_cvt_pk_bf16_f32 v34, v36, v37
    v_exp_f32 v39, v39
    v_exp_f32 v40, v40
    v_cvt_pk_bf16_f32 v35, v38, v39
    v_mfma_f32_32x32x16_bf16 v[48:63], v[100:103], v[12:15], v[48:63]
    v_exp_f32 v41, v41
    v_exp_f32 v42, v42
    v_cvt_pk_bf16_f32 v36, v40, v41
    v_exp_f32 v43, v43
    v_exp_f32 v44, v44
    v_cvt_pk_bf16_f32 v37, v42, v43
    v_exp_f32 v45, v45
    v_exp_f32 v46, v46
    v_exp_f32 v47, v47
    v_cvt_pk_bf16_f32 v38, v44, v45
    v_cvt_pk_bf16_f32 v39, v46, v47
    s_waitcnt lgkmcnt(0)
    v_mfma_f32_32x32x16_bf16 v[64:79], v[104:107], v[32:35], v[64:79]
    ds_read_b128 v[112:115], v3 offset:22528
    ds_read_b128 v[116:119], v3 offset:23552
    v_exp_f32 v48, v48
    v_exp_f32 v49, v49
    v_exp_f32 v50, v50
    v_mfma_f32_32x32x16_bf16 v[64:79], v[108:111], v[36:39], v[64:79]
    ds_read_b128 v[96:99], v3 offset:28672
    ds_read_b128 v[100:103], v3 offset:29696
    v_exp_f32 v51, v51
    v_cvt_pk_bf16_f32 v48, v48, v49
    v_exp_f32 v52, v52
    v_cvt_pk_bf16_f32 v49, v50, v51
    v_mfma_f32_16x16x32_bf16 v[80:83], v[84:87], v[32:35], v[80:83]
    v_exp_f32 v53, v53
    v_mfma_f32_16x16x32_bf16 v[80:83], v[84:87], v[36:39], v[80:83]
    v_exp_f32 v54, v54
    v_mfma_f32_32x32x16_bf16 v[32:47], v[88:91], v[8:11], v[16:31]
    v_cvt_pk_bf16_f32 v50, v52, v53
    v_exp_f32 v55, v55
    v_exp_f32 v56, v56
    v_cvt_pk_bf16_f32 v51, v54, v55
    v_mfma_f32_32x32x16_bf16 v[32:47], v[92:95], v[12:15], v[32:47]
    v_exp_f32 v57, v57
    v_exp_f32 v58, v58
    v_cvt_pk_bf16_f32 v52, v56, v57
    v_exp_f32 v59, v59
    v_exp_f32 v60, v60
    v_cvt_pk_bf16_f32 v53, v58, v59
    v_exp_f32 v61, v61
    v_exp_f32 v62, v62
    v_exp_f32 v63, v63
    v_cvt_pk_bf16_f32 v54, v60, v61
    v_cvt_pk_bf16_f32 v55, v62, v63
    s_waitcnt lgkmcnt(0)
    v_mfma_f32_32x32x16_bf16 v[64:79], v[112:115], v[48:51], v[64:79]
    ds_read_b128 v[104:107], v3 offset:26624
    ds_read_b128 v[108:111], v3 offset:27648
    v_exp_f32 v32, v32
    v_exp_f32 v33, v33
    v_exp_f32 v34, v34
    v_mfma_f32_32x32x16_bf16 v[64:79], v[116:119], v[52:55], v[64:79]
    ds_read_b128 v[88:91], v3 offset:32768
    ds_read_b128 v[92:95], v3 offset:33792
    v_exp_f32 v35, v35
    v_cvt_pk_bf16_f32 v32, v32, v33
    v_exp_f32 v36, v36
    v_cvt_pk_bf16_f32 v33, v34, v35
    v_mfma_f32_16x16x32_bf16 v[80:83], v[84:87], v[48:51], v[80:83]
    v_exp_f32 v37, v37
    v_mfma_f32_16x16x32_bf16 v[80:83], v[84:87], v[52:55], v[80:83]
    v_exp_f32 v38, v38
    v_mfma_f32_32x32x16_bf16 v[48:63], v[96:99], v[8:11], v[16:31]
    v_cvt_pk_bf16_f32 v34, v36, v37
    v_exp_f32 v39, v39
    v_exp_f32 v40, v40
    v_cvt_pk_bf16_f32 v35, v38, v39
    v_mfma_f32_32x32x16_bf16 v[48:63], v[100:103], v[12:15], v[48:63]
    v_exp_f32 v41, v41
    v_exp_f32 v42, v42
    v_cvt_pk_bf16_f32 v36, v40, v41
    v_exp_f32 v43, v43
    v_exp_f32 v44, v44
    v_cvt_pk_bf16_f32 v37, v42, v43
    v_exp_f32 v45, v45
    v_exp_f32 v46, v46
    v_exp_f32 v47, v47
    v_cvt_pk_bf16_f32 v38, v44, v45
    v_cvt_pk_bf16_f32 v39, v46, v47
    s_waitcnt lgkmcnt(0)
    v_mfma_f32_32x32x16_bf16 v[64:79], v[104:107], v[32:35], v[64:79]
    ds_read_b128 v[112:115], v3 offset:30720
    ds_read_b128 v[116:119], v3 offset:31744
    v_exp_f32 v48, v48
    v_exp_f32 v49, v49
    v_exp_f32 v50, v50
    v_mfma_f32_32x32x16_bf16 v[64:79], v[108:111], v[36:39], v[64:79]
    ds_read_b128 v[96:99], v3 offset:36864
    ds_read_b128 v[100:103], v3 offset:37888
    v_exp_f32 v51, v51
    v_cvt_pk_bf16_f32 v48, v48, v49
    v_exp_f32 v52, v52
    v_cvt_pk_bf16_f32 v49, v50, v51
    v_mfma_f32_16x16x32_bf16 v[80:83], v[84:87], v[32:35], v[80:83]
    v_exp_f32 v53, v53
    v_mfma_f32_16x16x32_bf16 v[80:83], v[84:87], v[36:39], v[80:83]
    v_exp_f32 v54, v54
    v_mfma_f32_32x32x16_bf16 v[32:47], v[88:91], v[8:11], v[16:31]
    v_cvt_pk_bf16_f32 v50, v52, v53
    v_exp_f32 v55, v55
    v_exp_f32 v56, v56
    v_cvt_pk_bf16_f32 v51, v54, v55
    v_mfma_f32_32x32x16_bf16 v[32:47], v[92:95], v[12:15], v[32:47]
    v_exp_f32 v57, v57
    v_exp_f32 v58, v58
    v_cvt_pk_bf16_f32 v52, v56, v57
    v_exp_f32 v59, v59
    v_exp_f32 v60, v60
    v_cvt_pk_bf16_f32 v53, v58, v59
    v_exp_f32 v61, v61
    v_exp_f32 v62, v62
    v_exp_f32 v63, v63
    v_cvt_pk_bf16_f32 v54, v60, v61
    v_cvt_pk_bf16_f32 v55, v62, v63
    s_waitcnt lgkmcnt(0)
    v_mfma_f32_32x32x16_bf16 v[64:79], v[112:115], v[48:51], v[64:79]
    ds_read_b128 v[104:107], v3 offset:34816
    ds_read_b128 v[108:111], v3 offset:35840
    v_exp_f32 v32, v32
    v_exp_f32 v33, v33
    v_exp_f32 v34, v34
    v_mfma_f32_32x32x16_bf16 v[64:79], v[116:119], v[52:55], v[64:79]
    ds_read_b128 v[88:91], v3 offset:40960
    ds_read_b128 v[92:95], v3 offset:41984
    v_exp_f32 v35, v35
    v_cvt_pk_bf16_f32 v32, v32, v33
    v_exp_f32 v36, v36
    v_cvt_pk_bf16_f32 v33, v34, v35
    v_mfma_f32_16x16x32_bf16 v[80:83], v[84:87], v[48:51], v[80:83]
    v_exp_f32 v37, v37
    v_mfma_f32_16x16x32_bf16 v[80:83], v[84:87], v[52:55], v[80:83]
    v_exp_f32 v38, v38
    v_mfma_f32_32x32x16_bf16 v[48:63], v[96:99], v[8:11], v[16:31]
    v_cvt_pk_bf16_f32 v34, v36, v37
    v_exp_f32 v39, v39
    v_exp_f32 v40, v40
    v_cvt_pk_bf16_f32 v35, v38, v39
    v_mfma_f32_32x32x16_bf16 v[48:63], v[100:103], v[12:15], v[48:63]
    v_exp_f32 v41, v41
    v_exp_f32 v42, v42
    v_cvt_pk_bf16_f32 v36, v40, v41
    v_exp_f32 v43, v43
    v_exp_f32 v44, v44
    v_cvt_pk_bf16_f32 v37, v42, v43
    v_exp_f32 v45, v45
    v_exp_f32 v46, v46
    v_exp_f32 v47, v47
    v_cvt_pk_bf16_f32 v38, v44, v45
    v_cvt_pk_bf16_f32 v39, v46, v47
    s_waitcnt lgkmcnt(0)
    v_mfma_f32_32x32x16_bf16 v[64:79], v[104:107], v[32:35], v[64:79]
    ds_read_b128 v[112:115], v3 offset:38912
    ds_read_b128 v[116:119], v3 offset:39936
    v_exp_f32 v48, v48
    v_exp_f32 v49, v49
    v_exp_f32 v50, v50
    v_mfma_f32_32x32x16_bf16 v[64:79], v[108:111], v[36:39], v[64:79]
    ds_read_b128 v[96:99], v3 offset:45056
    ds_read_b128 v[100:103], v3 offset:46080
    v_exp_f32 v51, v51
    v_cvt_pk_bf16_f32 v48, v48, v49
    v_exp_f32 v52, v52
    v_cvt_pk_bf16_f32 v49, v50, v51
    v_mfma_f32_16x16x32_bf16 v[80:83], v[84:87], v[32:35], v[80:83]
    v_exp_f32 v53, v53
    v_mfma_f32_16x16x32_bf16 v[80:83], v[84:87], v[36:39], v[80:83]
    v_exp_f32 v54, v54
    v_mfma_f32_32x32x16_bf16 v[32:47], v[88:91], v[8:11], v[16:31]
    v_cvt_pk_bf16_f32 v50, v52, v53
    v_exp_f32 v55, v55
    v_exp_f32 v56, v56
    v_cvt_pk_bf16_f32 v51, v54, v55
    v_mfma_f32_32x32x16_bf16 v[32:47], v[92:95], v[12:15], v[32:47]
    v_exp_f32 v57, v57
    v_exp_f32 v58, v58
    v_cvt_pk_bf16_f32 v52, v56, v57
    v_exp_f32 v59, v59
    v_exp_f32 v60, v60
    v_cvt_pk_bf16_f32 v53, v58, v59
    v_exp_f32 v61, v61
    v_exp_f32 v62, v62
    v_exp_f32 v63, v63
    v_cvt_pk_bf16_f32 v54, v60, v61
    v_cvt_pk_bf16_f32 v55, v62, v63
    s_waitcnt vmcnt(0) lgkmcnt(0)
    s_barrier
    s_mov_b32 m0, s31
    s_add_u32 s34, s32, 0x28000
    buffer_load_dwordx4 v3, s[20:23], s34 offen offset:0 lds
    buffer_load_dwordx4 v3, s[20:23], s34 offen offset:1024 lds
    buffer_load_dwordx4 v3, s[20:23], s34 offen offset:2048 lds
    buffer_load_dwordx4 v3, s[20:23], s34 offen offset:3072 lds
    v_mfma_f32_32x32x16_bf16 v[64:79], v[112:115], v[48:51], v[64:79]
    ds_read_b128 v[104:107], v3 offset:43008
    ds_read_b128 v[108:111], v3 offset:44032
    v_exp_f32 v32, v32
    v_exp_f32 v33, v33
    v_exp_f32 v34, v34
    v_mfma_f32_32x32x16_bf16 v[64:79], v[116:119], v[52:55], v[64:79]
    ds_read_b128 v[88:91], v3 offset:49152
    ds_read_b128 v[92:95], v3 offset:50176
    v_exp_f32 v35, v35
    v_cvt_pk_bf16_f32 v32, v32, v33
    v_exp_f32 v36, v36
    v_cvt_pk_bf16_f32 v33, v34, v35
    v_mfma_f32_16x16x32_bf16 v[80:83], v[84:87], v[48:51], v[80:83]
    v_exp_f32 v37, v37
    v_mfma_f32_16x16x32_bf16 v[80:83], v[84:87], v[52:55], v[80:83]
    v_exp_f32 v38, v38
    v_mfma_f32_32x32x16_bf16 v[48:63], v[96:99], v[8:11], v[16:31]
    v_cvt_pk_bf16_f32 v34, v36, v37
    v_exp_f32 v39, v39
    v_exp_f32 v40, v40
    v_cvt_pk_bf16_f32 v35, v38, v39
    v_mfma_f32_32x32x16_bf16 v[48:63], v[100:103], v[12:15], v[48:63]
    v_exp_f32 v41, v41
    v_exp_f32 v42, v42
    v_cvt_pk_bf16_f32 v36, v40, v41
    v_exp_f32 v43, v43
    v_exp_f32 v44, v44
    v_cvt_pk_bf16_f32 v37, v42, v43
    v_exp_f32 v45, v45
    v_exp_f32 v46, v46
    v_exp_f32 v47, v47
    v_cvt_pk_bf16_f32 v38, v44, v45
    v_cvt_pk_bf16_f32 v39, v46, v47
    s_waitcnt lgkmcnt(0)
    v_mfma_f32_32x32x16_bf16 v[64:79], v[104:107], v[32:35], v[64:79]
    ds_read_b128 v[112:115], v3 offset:47104
    ds_read_b128 v[116:119], v3 offset:48128
    v_exp_f32 v48, v48
    v_exp_f32 v49, v49
    v_exp_f32 v50, v50
    v_mfma_f32_32x32x16_bf16 v[64:79], v[108:111], v[36:39], v[64:79]
    ds_read_b128 v[96:99], v3 offset:53248
    ds_read_b128 v[100:103], v3 offset:54272
    v_exp_f32 v51, v51
    v_cvt_pk_bf16_f32 v48, v48, v49
    v_exp_f32 v52, v52
    v_cvt_pk_bf16_f32 v49, v50, v51
    v_mfma_f32_16x16x32_bf16 v[80:83], v[84:87], v[32:35], v[80:83]
    v_exp_f32 v53, v53
    v_mfma_f32_16x16x32_bf16 v[80:83], v[84:87], v[36:39], v[80:83]
    v_exp_f32 v54, v54
    v_mfma_f32_32x32x16_bf16 v[32:47], v[88:91], v[8:11], v[16:31]
    v_cvt_pk_bf16_f32 v50, v52, v53
    v_exp_f32 v55, v55
    v_exp_f32 v56, v56
    v_cvt_pk_bf16_f32 v51, v54, v55
    v_mfma_f32_32x32x16_bf16 v[32:47], v[92:95], v[12:15], v[32:47]
    v_exp_f32 v57, v57
    v_exp_f32 v58, v58
    v_cvt_pk_bf16_f32 v52, v56, v57
    v_exp_f32 v59, v59
    v_exp_f32 v60, v60
    v_cvt_pk_bf16_f32 v53, v58, v59
    v_exp_f32 v61, v61
    v_exp_f32 v62, v62
    v_exp_f32 v63, v63
    v_cvt_pk_bf16_f32 v54, v60, v61
    v_cvt_pk_bf16_f32 v55, v62, v63
    s_waitcnt lgkmcnt(0)
    v_mfma_f32_32x32x16_bf16 v[64:79], v[112:115], v[48:51], v[64:79]
    ds_read_b128 v[104:107], v3 offset:51200
    ds_read_b128 v[108:111], v3 offset:52224
    v_exp_f32 v32, v32
    v_exp_f32 v33, v33
    v_exp_f32 v34, v34
    v_mfma_f32_32x32x16_bf16 v[64:79], v[116:119], v[52:55], v[64:79]
    ds_read_b128 v[88:91], v3 offset:57344
    ds_read_b128 v[92:95], v3 offset:58368
    v_exp_f32 v35, v35
    v_cvt_pk_bf16_f32 v32, v32, v33
    v_exp_f32 v36, v36
    v_cvt_pk_bf16_f32 v33, v34, v35
    v_mfma_f32_16x16x32_bf16 v[80:83], v[84:87], v[48:51], v[80:83]
    v_exp_f32 v37, v37
    v_mfma_f32_16x16x32_bf16 v[80:83], v[84:87], v[52:55], v[80:83]
    v_exp_f32 v38, v38
    v_mfma_f32_32x32x16_bf16 v[48:63], v[96:99], v[8:11], v[16:31]
    v_cvt_pk_bf16_f32 v34, v36, v37
    v_exp_f32 v39, v39
    v_exp_f32 v40, v40
    v_cvt_pk_bf16_f32 v35, v38, v39
    v_mfma_f32_32x32x16_bf16 v[48:63], v[100:103], v[12:15], v[48:63]
    v_exp_f32 v41, v41
    v_exp_f32 v42, v42
    v_cvt_pk_bf16_f32 v36, v40, v41
    v_exp_f32 v43, v43
    v_exp_f32 v44, v44
    v_cvt_pk_bf16_f32 v37, v42, v43
    v_exp_f32 v45, v45
    v_exp_f32 v46, v46
    v_exp_f32 v47, v47
    v_cvt_pk_bf16_f32 v38, v44, v45
    v_cvt_pk_bf16_f32 v39, v46, v47
    s_waitcnt lgkmcnt(0)
    v_mfma_f32_32x32x16_bf16 v[64:79], v[104:107], v[32:35], v[64:79]
    ds_read_b128 v[112:115], v3 offset:55296
    ds_read_b128 v[116:119], v3 offset:56320
    v_exp_f32 v48, v48
    v_exp_f32 v49, v49
    v_exp_f32 v50, v50
    v_mfma_f32_32x32x16_bf16 v[64:79], v[108:111], v[36:39], v[64:79]
    ds_read_b128 v[96:99], v3 offset:61440
    ds_read_b128 v[100:103], v3 offset:62464
    v_exp_f32 v51, v51
    v_cvt_pk_bf16_f32 v48, v48, v49
    v_exp_f32 v52, v52
    v_cvt_pk_bf16_f32 v49, v50, v51
    v_mfma_f32_16x16x32_bf16 v[80:83], v[84:87], v[32:35], v[80:83]
    v_exp_f32 v53, v53
    v_mfma_f32_16x16x32_bf16 v[80:83], v[84:87], v[36:39], v[80:83]
    v_exp_f32 v54, v54
    v_mfma_f32_32x32x16_bf16 v[32:47], v[88:91], v[8:11], v[16:31]
    v_cvt_pk_bf16_f32 v50, v52, v53
    v_exp_f32 v55, v55
    v_exp_f32 v56, v56
    v_cvt_pk_bf16_f32 v51, v54, v55
    v_mfma_f32_32x32x16_bf16 v[32:47], v[92:95], v[12:15], v[32:47]
    v_exp_f32 v57, v57
    v_exp_f32 v58, v58
    v_cvt_pk_bf16_f32 v52, v56, v57
    v_exp_f32 v59, v59
    v_exp_f32 v60, v60
    v_cvt_pk_bf16_f32 v53, v58, v59
    v_exp_f32 v61, v61
    v_exp_f32 v62, v62
    v_exp_f32 v63, v63
    v_cvt_pk_bf16_f32 v54, v60, v61
    v_cvt_pk_bf16_f32 v55, v62, v63
    s_waitcnt lgkmcnt(0)
    v_mfma_f32_32x32x16_bf16 v[64:79], v[112:115], v[48:51], v[64:79]
    ds_read_b128 v[104:107], v3 offset:59392
    ds_read_b128 v[108:111], v3 offset:60416
    v_exp_f32 v32, v32
    v_exp_f32 v33, v33
    v_exp_f32 v34, v34
    v_mfma_f32_32x32x16_bf16 v[64:79], v[116:119], v[52:55], v[64:79]
    ds_read_b128 v[88:91], v4 offset:0
    ds_read_b128 v[92:95], v4 offset:1024
    v_exp_f32 v35, v35
    v_cvt_pk_bf16_f32 v32, v32, v33
    v_exp_f32 v36, v36
    v_cvt_pk_bf16_f32 v33, v34, v35
    v_mfma_f32_16x16x32_bf16 v[80:83], v[84:87], v[48:51], v[80:83]
    v_exp_f32 v37, v37
    v_mfma_f32_16x16x32_bf16 v[80:83], v[84:87], v[52:55], v[80:83]
    v_exp_f32 v38, v38
    v_mfma_f32_32x32x16_bf16 v[48:63], v[96:99], v[8:11], v[16:31]
    v_cvt_pk_bf16_f32 v34, v36, v37
    v_exp_f32 v39, v39
    v_exp_f32 v40, v40
    v_cvt_pk_bf16_f32 v35, v38, v39
    v_mfma_f32_32x32x16_bf16 v[48:63], v[100:103], v[12:15], v[48:63]
    v_exp_f32 v41, v41
    v_exp_f32 v42, v42
    v_cvt_pk_bf16_f32 v36, v40, v41
    v_exp_f32 v43, v43
    v_exp_f32 v44, v44
    v_cvt_pk_bf16_f32 v37, v42, v43
    v_exp_f32 v45, v45
    v_exp_f32 v46, v46
    v_exp_f32 v47, v47
    v_cvt_pk_bf16_f32 v38, v44, v45
    v_cvt_pk_bf16_f32 v39, v46, v47
    s_waitcnt lgkmcnt(0)
    v_mfma_f32_32x32x16_bf16 v[64:79], v[104:107], v[32:35], v[64:79]
    ds_read_b128 v[112:115], v3 offset:63488
    ds_read_b128 v[116:119], v3 offset:64512
    v_exp_f32 v48, v48
    v_exp_f32 v49, v49
    v_exp_f32 v50, v50
    v_mfma_f32_32x32x16_bf16 v[64:79], v[108:111], v[36:39], v[64:79]
    ds_read_b128 v[96:99], v4 offset:4096
    ds_read_b128 v[100:103], v4 offset:5120
    v_exp_f32 v51, v51
    v_cvt_pk_bf16_f32 v48, v48, v49
    v_exp_f32 v52, v52
    v_cvt_pk_bf16_f32 v49, v50, v51
    v_mfma_f32_16x16x32_bf16 v[80:83], v[84:87], v[32:35], v[80:83]
    v_exp_f32 v53, v53
    v_mfma_f32_16x16x32_bf16 v[80:83], v[84:87], v[36:39], v[80:83]
    v_exp_f32 v54, v54
    v_mfma_f32_32x32x16_bf16 v[32:47], v[88:91], v[8:11], v[16:31]
    v_cvt_pk_bf16_f32 v50, v52, v53
    v_exp_f32 v55, v55
    v_exp_f32 v56, v56
    v_cvt_pk_bf16_f32 v51, v54, v55
    v_mfma_f32_32x32x16_bf16 v[32:47], v[92:95], v[12:15], v[32:47]
    v_exp_f32 v57, v57
    v_exp_f32 v58, v58
    v_cvt_pk_bf16_f32 v52, v56, v57
    v_exp_f32 v59, v59
    v_exp_f32 v60, v60
    v_cvt_pk_bf16_f32 v53, v58, v59
    v_exp_f32 v61, v61
    v_exp_f32 v62, v62
    v_exp_f32 v63, v63
    v_cvt_pk_bf16_f32 v54, v60, v61
    v_cvt_pk_bf16_f32 v55, v62, v63
    s_waitcnt lgkmcnt(0)
    v_mfma_f32_32x32x16_bf16 v[64:79], v[112:115], v[48:51], v[64:79]
    ds_read_b128 v[104:107], v4 offset:2048
    ds_read_b128 v[108:111], v4 offset:3072
    v_exp_f32 v32, v32
    v_exp_f32 v33, v33
    v_exp_f32 v34, v34
    v_mfma_f32_32x32x16_bf16 v[64:79], v[116:119], v[52:55], v[64:79]
    ds_read_b128 v[88:91], v4 offset:8192
    ds_read_b128 v[92:95], v4 offset:9216
    v_exp_f32 v35, v35
    v_cvt_pk_bf16_f32 v32, v32, v33
    v_exp_f32 v36, v36
    v_cvt_pk_bf16_f32 v33, v34, v35
    v_mfma_f32_16x16x32_bf16 v[80:83], v[84:87], v[48:51], v[80:83]
    v_exp_f32 v37, v37
    v_mfma_f32_16x16x32_bf16 v[80:83], v[84:87], v[52:55], v[80:83]
    v_exp_f32 v38, v38
    v_mfma_f32_32x32x16_bf16 v[48:63], v[96:99], v[8:11], v[16:31]
    v_cvt_pk_bf16_f32 v34, v36, v37
    v_exp_f32 v39, v39
    v_exp_f32 v40, v40
    v_cvt_pk_bf16_f32 v35, v38, v39
    v_mfma_f32_32x32x16_bf16 v[48:63], v[100:103], v[12:15], v[48:63]
    v_exp_f32 v41, v41
    v_exp_f32 v42, v42
    v_cvt_pk_bf16_f32 v36, v40, v41
    v_exp_f32 v43, v43
    v_exp_f32 v44, v44
    v_cvt_pk_bf16_f32 v37, v42, v43
    v_exp_f32 v45, v45
    v_exp_f32 v46, v46
    v_exp_f32 v47, v47
    v_cvt_pk_bf16_f32 v38, v44, v45
    v_cvt_pk_bf16_f32 v39, v46, v47
    s_waitcnt lgkmcnt(0)
    v_mfma_f32_32x32x16_bf16 v[64:79], v[104:107], v[32:35], v[64:79]
    ds_read_b128 v[112:115], v4 offset:6144
    ds_read_b128 v[116:119], v4 offset:7168
    v_exp_f32 v48, v48
    v_exp_f32 v49, v49
    v_exp_f32 v50, v50
    v_mfma_f32_32x32x16_bf16 v[64:79], v[108:111], v[36:39], v[64:79]
    ds_read_b128 v[96:99], v4 offset:12288
    ds_read_b128 v[100:103], v4 offset:13312
    v_exp_f32 v51, v51
    v_cvt_pk_bf16_f32 v48, v48, v49
    v_exp_f32 v52, v52
    v_cvt_pk_bf16_f32 v49, v50, v51
    v_mfma_f32_16x16x32_bf16 v[80:83], v[84:87], v[32:35], v[80:83]
    v_exp_f32 v53, v53
    v_mfma_f32_16x16x32_bf16 v[80:83], v[84:87], v[36:39], v[80:83]
    v_exp_f32 v54, v54
    v_mfma_f32_32x32x16_bf16 v[32:47], v[88:91], v[8:11], v[16:31]
    v_cvt_pk_bf16_f32 v50, v52, v53
    v_exp_f32 v55, v55
    v_exp_f32 v56, v56
    v_cvt_pk_bf16_f32 v51, v54, v55
    v_mfma_f32_32x32x16_bf16 v[32:47], v[92:95], v[12:15], v[32:47]
    v_exp_f32 v57, v57
    v_exp_f32 v58, v58
    v_cvt_pk_bf16_f32 v52, v56, v57
    v_exp_f32 v59, v59
    v_exp_f32 v60, v60
    v_cvt_pk_bf16_f32 v53, v58, v59
    v_exp_f32 v61, v61
    v_exp_f32 v62, v62
    v_exp_f32 v63, v63
    v_cvt_pk_bf16_f32 v54, v60, v61
    v_cvt_pk_bf16_f32 v55, v62, v63
    s_waitcnt vmcnt(0) lgkmcnt(0)
    s_barrier
    s_add_u32 m0, s31, 0x8000
    s_add_u32 s34, s32, 0x30000
    buffer_load_dwordx4 v3, s[20:23], s34 offen offset:0 lds
    buffer_load_dwordx4 v3, s[20:23], s34 offen offset:1024 lds
    buffer_load_dwordx4 v3, s[20:23], s34 offen offset:2048 lds
    buffer_load_dwordx4 v3, s[20:23], s34 offen offset:3072 lds
    v_mfma_f32_32x32x16_bf16 v[64:79], v[112:115], v[48:51], v[64:79]
    ds_read_b128 v[104:107], v4 offset:10240
    ds_read_b128 v[108:111], v4 offset:11264
    v_exp_f32 v32, v32
    v_exp_f32 v33, v33
    v_exp_f32 v34, v34
    v_mfma_f32_32x32x16_bf16 v[64:79], v[116:119], v[52:55], v[64:79]
    ds_read_b128 v[88:91], v3 offset:0
    ds_read_b128 v[92:95], v3 offset:1024
    v_exp_f32 v35, v35
    v_cvt_pk_bf16_f32 v32, v32, v33
    v_exp_f32 v36, v36
    v_cvt_pk_bf16_f32 v33, v34, v35
    v_mfma_f32_16x16x32_bf16 v[80:83], v[84:87], v[48:51], v[80:83]
    v_exp_f32 v37, v37
    v_mfma_f32_16x16x32_bf16 v[80:83], v[84:87], v[52:55], v[80:83]
    v_exp_f32 v38, v38
    v_mfma_f32_32x32x16_bf16 v[48:63], v[96:99], v[8:11], v[16:31]
    v_cvt_pk_bf16_f32 v34, v36, v37
    v_exp_f32 v39, v39
    v_exp_f32 v40, v40
    v_cvt_pk_bf16_f32 v35, v38, v39
    v_mfma_f32_32x32x16_bf16 v[48:63], v[100:103], v[12:15], v[48:63]
    v_exp_f32 v41, v41
    v_exp_f32 v42, v42
    v_cvt_pk_bf16_f32 v36, v40, v41
    v_exp_f32 v43, v43
    v_exp_f32 v44, v44
    v_cvt_pk_bf16_f32 v37, v42, v43
    v_exp_f32 v45, v45
    v_exp_f32 v46, v46
    v_exp_f32 v47, v47
    v_cvt_pk_bf16_f32 v38, v44, v45
    v_cvt_pk_bf16_f32 v39, v46, v47
    s_waitcnt lgkmcnt(0)
    v_mfma_f32_32x32x16_bf16 v[64:79], v[104:107], v[32:35], v[64:79]
    ds_read_b128 v[112:115], v4 offset:14336
    ds_read_b128 v[116:119], v4 offset:15360
    v_exp_f32 v48, v48
    v_exp_f32 v49, v49
    v_exp_f32 v50, v50
    v_mfma_f32_32x32x16_bf16 v[64:79], v[108:111], v[36:39], v[64:79]
    ds_read_b128 v[96:99], v3 offset:4096
    ds_read_b128 v[100:103], v3 offset:5120
    v_exp_f32 v51, v51
    v_cvt_pk_bf16_f32 v48, v48, v49
    v_exp_f32 v52, v52
    v_cvt_pk_bf16_f32 v49, v50, v51
    v_mfma_f32_16x16x32_bf16 v[80:83], v[84:87], v[32:35], v[80:83]
    v_exp_f32 v53, v53
    v_mfma_f32_16x16x32_bf16 v[80:83], v[84:87], v[36:39], v[80:83]
    v_exp_f32 v54, v54
    v_mfma_f32_32x32x16_bf16 v[32:47], v[88:91], v[8:11], v[16:31]
    v_cvt_pk_bf16_f32 v50, v52, v53
    v_exp_f32 v55, v55
    v_exp_f32 v56, v56
    v_cvt_pk_bf16_f32 v51, v54, v55
    v_mfma_f32_32x32x16_bf16 v[32:47], v[92:95], v[12:15], v[32:47]
    v_exp_f32 v57, v57
    v_exp_f32 v58, v58
    v_cvt_pk_bf16_f32 v52, v56, v57
    v_exp_f32 v59, v59
    v_exp_f32 v60, v60
    v_cvt_pk_bf16_f32 v53, v58, v59
    v_exp_f32 v61, v61
    v_exp_f32 v62, v62
    v_exp_f32 v63, v63
    v_cvt_pk_bf16_f32 v54, v60, v61
    v_cvt_pk_bf16_f32 v55, v62, v63
    s_waitcnt lgkmcnt(0)
    v_mfma_f32_32x32x16_bf16 v[64:79], v[112:115], v[48:51], v[64:79]
    ds_read_b128 v[104:107], v3 offset:2048
    ds_read_b128 v[108:111], v3 offset:3072
    v_exp_f32 v32, v32
    v_exp_f32 v33, v33
    v_exp_f32 v34, v34
    v_mfma_f32_32x32x16_bf16 v[64:79], v[116:119], v[52:55], v[64:79]
    ds_read_b128 v[88:91], v3 offset:8192
    ds_read_b128 v[92:95], v3 offset:9216
    v_exp_f32 v35, v35
    v_cvt_pk_bf16_f32 v32, v32, v33
    v_exp_f32 v36, v36
    v_cvt_pk_bf16_f32 v33, v34, v35
    v_mfma_f32_16x16x32_bf16 v[80:83], v[84:87], v[48:51], v[80:83]
    v_exp_f32 v37, v37
    v_mfma_f32_16x16x32_bf16 v[80:83], v[84:87], v[52:55], v[80:83]
    v_exp_f32 v38, v38
    v_mfma_f32_32x32x16_bf16 v[48:63], v[96:99], v[8:11], v[16:31]
    v_cvt_pk_bf16_f32 v34, v36, v37
    v_exp_f32 v39, v39
    v_exp_f32 v40, v40
    v_cvt_pk_bf16_f32 v35, v38, v39
    v_mfma_f32_32x32x16_bf16 v[48:63], v[100:103], v[12:15], v[48:63]
    v_exp_f32 v41, v41
    v_exp_f32 v42, v42
    v_cvt_pk_bf16_f32 v36, v40, v41
    v_exp_f32 v43, v43
    v_exp_f32 v44, v44
    v_cvt_pk_bf16_f32 v37, v42, v43
    v_exp_f32 v45, v45
    v_exp_f32 v46, v46
    v_exp_f32 v47, v47
    v_cvt_pk_bf16_f32 v38, v44, v45
    v_cvt_pk_bf16_f32 v39, v46, v47
    s_waitcnt lgkmcnt(0)
    v_mfma_f32_32x32x16_bf16 v[64:79], v[104:107], v[32:35], v[64:79]
    ds_read_b128 v[112:115], v3 offset:6144
    ds_read_b128 v[116:119], v3 offset:7168
    v_exp_f32 v48, v48
    v_exp_f32 v49, v49
    v_exp_f32 v50, v50
    v_mfma_f32_32x32x16_bf16 v[64:79], v[108:111], v[36:39], v[64:79]
    ds_read_b128 v[96:99], v3 offset:12288
    ds_read_b128 v[100:103], v3 offset:13312
    v_exp_f32 v51, v51
    v_cvt_pk_bf16_f32 v48, v48, v49
    v_exp_f32 v52, v52
    v_cvt_pk_bf16_f32 v49, v50, v51
    v_mfma_f32_16x16x32_bf16 v[80:83], v[84:87], v[32:35], v[80:83]
    v_exp_f32 v53, v53
    v_mfma_f32_16x16x32_bf16 v[80:83], v[84:87], v[36:39], v[80:83]
    v_exp_f32 v54, v54
    v_mfma_f32_32x32x16_bf16 v[32:47], v[88:91], v[8:11], v[16:31]
    v_cvt_pk_bf16_f32 v50, v52, v53
    v_exp_f32 v55, v55
    v_exp_f32 v56, v56
    v_cvt_pk_bf16_f32 v51, v54, v55
    v_mfma_f32_32x32x16_bf16 v[32:47], v[92:95], v[12:15], v[32:47]
    v_exp_f32 v57, v57
    v_exp_f32 v58, v58
    v_cvt_pk_bf16_f32 v52, v56, v57
    v_exp_f32 v59, v59
    v_exp_f32 v60, v60
    v_cvt_pk_bf16_f32 v53, v58, v59
    v_exp_f32 v61, v61
    v_exp_f32 v62, v62
    v_exp_f32 v63, v63
    v_cvt_pk_bf16_f32 v54, v60, v61
    v_cvt_pk_bf16_f32 v55, v62, v63
    s_waitcnt lgkmcnt(0)
    v_mfma_f32_32x32x16_bf16 v[64:79], v[112:115], v[48:51], v[64:79]
    ds_read_b128 v[104:107], v3 offset:10240
    ds_read_b128 v[108:111], v3 offset:11264
    v_exp_f32 v32, v32
    v_exp_f32 v33, v33
    v_exp_f32 v34, v34
    v_mfma_f32_32x32x16_bf16 v[64:79], v[116:119], v[52:55], v[64:79]
    ds_read_b128 v[88:91], v3 offset:16384
    ds_read_b128 v[92:95], v3 offset:17408
    v_exp_f32 v35, v35
    v_cvt_pk_bf16_f32 v32, v32, v33
    v_exp_f32 v36, v36
    v_cvt_pk_bf16_f32 v33, v34, v35
    v_mfma_f32_16x16x32_bf16 v[80:83], v[84:87], v[48:51], v[80:83]
    v_exp_f32 v37, v37
    v_mfma_f32_16x16x32_bf16 v[80:83], v[84:87], v[52:55], v[80:83]
    v_exp_f32 v38, v38
    v_mfma_f32_32x32x16_bf16 v[48:63], v[96:99], v[8:11], v[16:31]
    v_cvt_pk_bf16_f32 v34, v36, v37
    v_exp_f32 v39, v39
    v_exp_f32 v40, v40
    v_cvt_pk_bf16_f32 v35, v38, v39
    v_mfma_f32_32x32x16_bf16 v[48:63], v[100:103], v[12:15], v[48:63]
    v_exp_f32 v41, v41
    v_exp_f32 v42, v42
    v_cvt_pk_bf16_f32 v36, v40, v41
    v_exp_f32 v43, v43
    v_exp_f32 v44, v44
    v_cvt_pk_bf16_f32 v37, v42, v43
    v_exp_f32 v45, v45
    v_exp_f32 v46, v46
    v_exp_f32 v47, v47
    v_cvt_pk_bf16_f32 v38, v44, v45
    v_cvt_pk_bf16_f32 v39, v46, v47
    s_waitcnt lgkmcnt(0)
    v_mfma_f32_32x32x16_bf16 v[64:79], v[104:107], v[32:35], v[64:79]
    ds_read_b128 v[112:115], v3 offset:14336
    ds_read_b128 v[116:119], v3 offset:15360
    v_exp_f32 v48, v48
    v_exp_f32 v49, v49
    v_exp_f32 v50, v50
    v_mfma_f32_32x32x16_bf16 v[64:79], v[108:111], v[36:39], v[64:79]
    ds_read_b128 v[96:99], v3 offset:20480
    ds_read_b128 v[100:103], v3 offset:21504
    v_exp_f32 v51, v51
    v_cvt_pk_bf16_f32 v48, v48, v49
    v_exp_f32 v52, v52
    v_cvt_pk_bf16_f32 v49, v50, v51
    v_mfma_f32_16x16x32_bf16 v[80:83], v[84:87], v[32:35], v[80:83]
    v_exp_f32 v53, v53
    v_mfma_f32_16x16x32_bf16 v[80:83], v[84:87], v[36:39], v[80:83]
    v_exp_f32 v54, v54
    v_mfma_f32_32x32x16_bf16 v[32:47], v[88:91], v[8:11], v[16:31]
    v_cvt_pk_bf16_f32 v50, v52, v53
    v_exp_f32 v55, v55
    v_exp_f32 v56, v56
    v_cvt_pk_bf16_f32 v51, v54, v55
    v_mfma_f32_32x32x16_bf16 v[32:47], v[92:95], v[12:15], v[32:47]
    v_exp_f32 v57, v57
    v_exp_f32 v58, v58
    v_cvt_pk_bf16_f32 v52, v56, v57
    v_exp_f32 v59, v59
    v_exp_f32 v60, v60
    v_cvt_pk_bf16_f32 v53, v58, v59
    v_exp_f32 v61, v61
    v_exp_f32 v62, v62
    v_exp_f32 v63, v63
    v_cvt_pk_bf16_f32 v54, v60, v61
    v_cvt_pk_bf16_f32 v55, v62, v63
    s_waitcnt lgkmcnt(0)
    v_mfma_f32_32x32x16_bf16 v[64:79], v[112:115], v[48:51], v[64:79]
    ds_read_b128 v[104:107], v3 offset:18432
    ds_read_b128 v[108:111], v3 offset:19456
    v_exp_f32 v32, v32
    v_exp_f32 v33, v33
    v_exp_f32 v34, v34
    v_mfma_f32_32x32x16_bf16 v[64:79], v[116:119], v[52:55], v[64:79]
    ds_read_b128 v[88:91], v3 offset:24576
    ds_read_b128 v[92:95], v3 offset:25600
    v_exp_f32 v35, v35
    v_cvt_pk_bf16_f32 v32, v32, v33
    v_exp_f32 v36, v36
    v_cvt_pk_bf16_f32 v33, v34, v35
    v_mfma_f32_16x16x32_bf16 v[80:83], v[84:87], v[48:51], v[80:83]
    v_exp_f32 v37, v37
    v_mfma_f32_16x16x32_bf16 v[80:83], v[84:87], v[52:55], v[80:83]
    v_exp_f32 v38, v38
    v_mfma_f32_32x32x16_bf16 v[48:63], v[96:99], v[8:11], v[16:31]
    v_cvt_pk_bf16_f32 v34, v36, v37
    v_exp_f32 v39, v39
    v_exp_f32 v40, v40
    v_cvt_pk_bf16_f32 v35, v38, v39
    v_mfma_f32_32x32x16_bf16 v[48:63], v[100:103], v[12:15], v[48:63]
    v_exp_f32 v41, v41
    v_exp_f32 v42, v42
    v_cvt_pk_bf16_f32 v36, v40, v41
    v_exp_f32 v43, v43
    v_exp_f32 v44, v44
    v_cvt_pk_bf16_f32 v37, v42, v43
    v_exp_f32 v45, v45
    v_exp_f32 v46, v46
    v_exp_f32 v47, v47
    v_cvt_pk_bf16_f32 v38, v44, v45
    v_cvt_pk_bf16_f32 v39, v46, v47
    s_waitcnt lgkmcnt(0)
    v_mfma_f32_32x32x16_bf16 v[64:79], v[104:107], v[32:35], v[64:79]
    ds_read_b128 v[112:115], v3 offset:22528
    ds_read_b128 v[116:119], v3 offset:23552
    v_exp_f32 v48, v48
    v_exp_f32 v49, v49
    v_exp_f32 v50, v50
    v_mfma_f32_32x32x16_bf16 v[64:79], v[108:111], v[36:39], v[64:79]
    ds_read_b128 v[96:99], v3 offset:28672
    ds_read_b128 v[100:103], v3 offset:29696
    v_exp_f32 v51, v51
    v_cvt_pk_bf16_f32 v48, v48, v49
    v_exp_f32 v52, v52
    v_cvt_pk_bf16_f32 v49, v50, v51
    v_mfma_f32_16x16x32_bf16 v[80:83], v[84:87], v[32:35], v[80:83]
    v_exp_f32 v53, v53
    v_mfma_f32_16x16x32_bf16 v[80:83], v[84:87], v[36:39], v[80:83]
    v_exp_f32 v54, v54
    v_mfma_f32_32x32x16_bf16 v[32:47], v[88:91], v[8:11], v[16:31]
    v_cvt_pk_bf16_f32 v50, v52, v53
    v_exp_f32 v55, v55
    v_exp_f32 v56, v56
    v_cvt_pk_bf16_f32 v51, v54, v55
    v_mfma_f32_32x32x16_bf16 v[32:47], v[92:95], v[12:15], v[32:47]
    v_exp_f32 v57, v57
    v_exp_f32 v58, v58
    v_cvt_pk_bf16_f32 v52, v56, v57
    v_exp_f32 v59, v59
    v_exp_f32 v60, v60
    v_cvt_pk_bf16_f32 v53, v58, v59
    v_exp_f32 v61, v61
    v_exp_f32 v62, v62
    v_exp_f32 v63, v63
    v_cvt_pk_bf16_f32 v54, v60, v61
    v_cvt_pk_bf16_f32 v55, v62, v63
    s_waitcnt vmcnt(0) lgkmcnt(0)
    s_barrier
    s_mov_b32 m0, s33
    s_add_u32 s34, s32, 0x38000
    buffer_load_dwordx4 v3, s[20:23], s34 offen offset:0 lds
    buffer_load_dwordx4 v3, s[20:23], s34 offen offset:1024 lds
    buffer_load_dwordx4 v3, s[20:23], s34 offen offset:2048 lds
    buffer_load_dwordx4 v3, s[20:23], s34 offen offset:3072 lds
    v_mfma_f32_32x32x16_bf16 v[64:79], v[112:115], v[48:51], v[64:79]
    ds_read_b128 v[104:107], v3 offset:26624
    ds_read_b128 v[108:111], v3 offset:27648
    v_exp_f32 v32, v32
    v_exp_f32 v33, v33
    v_exp_f32 v34, v34
    v_mfma_f32_32x32x16_bf16 v[64:79], v[116:119], v[52:55], v[64:79]
    ds_read_b128 v[88:91], v3 offset:32768
    ds_read_b128 v[92:95], v3 offset:33792
    v_exp_f32 v35, v35
    v_cvt_pk_bf16_f32 v32, v32, v33
    v_exp_f32 v36, v36
    v_cvt_pk_bf16_f32 v33, v34, v35
    v_mfma_f32_16x16x32_bf16 v[80:83], v[84:87], v[48:51], v[80:83]
    v_exp_f32 v37, v37
    v_mfma_f32_16x16x32_bf16 v[80:83], v[84:87], v[52:55], v[80:83]
    v_exp_f32 v38, v38
    v_mfma_f32_32x32x16_bf16 v[48:63], v[96:99], v[8:11], v[16:31]
    v_cvt_pk_bf16_f32 v34, v36, v37
    v_exp_f32 v39, v39
    v_exp_f32 v40, v40
    v_cvt_pk_bf16_f32 v35, v38, v39
    v_mfma_f32_32x32x16_bf16 v[48:63], v[100:103], v[12:15], v[48:63]
    v_exp_f32 v41, v41
    v_exp_f32 v42, v42
    v_cvt_pk_bf16_f32 v36, v40, v41
    v_exp_f32 v43, v43
    v_exp_f32 v44, v44
    v_cvt_pk_bf16_f32 v37, v42, v43
    v_exp_f32 v45, v45
    v_exp_f32 v46, v46
    v_exp_f32 v47, v47
    v_cvt_pk_bf16_f32 v38, v44, v45
    v_cvt_pk_bf16_f32 v39, v46, v47
    s_waitcnt lgkmcnt(0)
    v_mfma_f32_32x32x16_bf16 v[64:79], v[104:107], v[32:35], v[64:79]
    ds_read_b128 v[112:115], v3 offset:30720
    ds_read_b128 v[116:119], v3 offset:31744
    v_exp_f32 v48, v48
    v_exp_f32 v49, v49
    v_exp_f32 v50, v50
    v_mfma_f32_32x32x16_bf16 v[64:79], v[108:111], v[36:39], v[64:79]
    ds_read_b128 v[96:99], v3 offset:36864
    ds_read_b128 v[100:103], v3 offset:37888
    v_exp_f32 v51, v51
    v_cvt_pk_bf16_f32 v48, v48, v49
    v_exp_f32 v52, v52
    v_cvt_pk_bf16_f32 v49, v50, v51
    v_mfma_f32_16x16x32_bf16 v[80:83], v[84:87], v[32:35], v[80:83]
    v_exp_f32 v53, v53
    v_mfma_f32_16x16x32_bf16 v[80:83], v[84:87], v[36:39], v[80:83]
    v_exp_f32 v54, v54
    v_mfma_f32_32x32x16_bf16 v[32:47], v[88:91], v[8:11], v[16:31]
    v_cvt_pk_bf16_f32 v50, v52, v53
    v_exp_f32 v55, v55
    v_exp_f32 v56, v56
    v_cvt_pk_bf16_f32 v51, v54, v55
    v_mfma_f32_32x32x16_bf16 v[32:47], v[92:95], v[12:15], v[32:47]
    v_exp_f32 v57, v57
    v_exp_f32 v58, v58
    v_cvt_pk_bf16_f32 v52, v56, v57
    v_exp_f32 v59, v59
    v_exp_f32 v60, v60
    v_cvt_pk_bf16_f32 v53, v58, v59
    v_exp_f32 v61, v61
    v_exp_f32 v62, v62
    v_exp_f32 v63, v63
    v_cvt_pk_bf16_f32 v54, v60, v61
    v_cvt_pk_bf16_f32 v55, v62, v63
    s_waitcnt lgkmcnt(0)
    v_mfma_f32_32x32x16_bf16 v[64:79], v[112:115], v[48:51], v[64:79]
    ds_read_b128 v[104:107], v3 offset:34816
    ds_read_b128 v[108:111], v3 offset:35840
    v_exp_f32 v32, v32
    v_exp_f32 v33, v33
    v_exp_f32 v34, v34
    v_mfma_f32_32x32x16_bf16 v[64:79], v[116:119], v[52:55], v[64:79]
    ds_read_b128 v[88:91], v3 offset:40960
    ds_read_b128 v[92:95], v3 offset:41984
    v_exp_f32 v35, v35
    v_cvt_pk_bf16_f32 v32, v32, v33
    v_exp_f32 v36, v36
    v_cvt_pk_bf16_f32 v33, v34, v35
    v_mfma_f32_16x16x32_bf16 v[80:83], v[84:87], v[48:51], v[80:83]
    v_exp_f32 v37, v37
    v_mfma_f32_16x16x32_bf16 v[80:83], v[84:87], v[52:55], v[80:83]
    v_exp_f32 v38, v38
    v_mfma_f32_32x32x16_bf16 v[48:63], v[96:99], v[8:11], v[16:31]
    v_cvt_pk_bf16_f32 v34, v36, v37
    v_exp_f32 v39, v39
    v_exp_f32 v40, v40
    v_cvt_pk_bf16_f32 v35, v38, v39
    v_mfma_f32_32x32x16_bf16 v[48:63], v[100:103], v[12:15], v[48:63]
    v_exp_f32 v41, v41
    v_exp_f32 v42, v42
    v_cvt_pk_bf16_f32 v36, v40, v41
    v_exp_f32 v43, v43
    v_exp_f32 v44, v44
    v_cvt_pk_bf16_f32 v37, v42, v43
    v_exp_f32 v45, v45
    v_exp_f32 v46, v46
    v_exp_f32 v47, v47
    v_cvt_pk_bf16_f32 v38, v44, v45
    v_cvt_pk_bf16_f32 v39, v46, v47
    s_waitcnt lgkmcnt(0)
    v_mfma_f32_32x32x16_bf16 v[64:79], v[104:107], v[32:35], v[64:79]
    ds_read_b128 v[112:115], v3 offset:38912
    ds_read_b128 v[116:119], v3 offset:39936
    v_exp_f32 v48, v48
    v_exp_f32 v49, v49
    v_exp_f32 v50, v50
    v_mfma_f32_32x32x16_bf16 v[64:79], v[108:111], v[36:39], v[64:79]
    ds_read_b128 v[96:99], v3 offset:45056
    ds_read_b128 v[100:103], v3 offset:46080
    v_exp_f32 v51, v51
    v_cvt_pk_bf16_f32 v48, v48, v49
    v_exp_f32 v52, v52
    v_cvt_pk_bf16_f32 v49, v50, v51
    v_mfma_f32_16x16x32_bf16 v[80:83], v[84:87], v[32:35], v[80:83]
    v_exp_f32 v53, v53
    v_mfma_f32_16x16x32_bf16 v[80:83], v[84:87], v[36:39], v[80:83]
    v_exp_f32 v54, v54
    v_mfma_f32_32x32x16_bf16 v[32:47], v[88:91], v[8:11], v[16:31]
    v_cvt_pk_bf16_f32 v50, v52, v53
    v_exp_f32 v55, v55
    v_exp_f32 v56, v56
    v_cvt_pk_bf16_f32 v51, v54, v55
    v_mfma_f32_32x32x16_bf16 v[32:47], v[92:95], v[12:15], v[32:47]
    v_exp_f32 v57, v57
    v_exp_f32 v58, v58
    v_cvt_pk_bf16_f32 v52, v56, v57
    v_exp_f32 v59, v59
    v_exp_f32 v60, v60
    v_cvt_pk_bf16_f32 v53, v58, v59
    v_exp_f32 v61, v61
    v_exp_f32 v62, v62
    v_exp_f32 v63, v63
    v_cvt_pk_bf16_f32 v54, v60, v61
    v_cvt_pk_bf16_f32 v55, v62, v63
    s_waitcnt lgkmcnt(0)
    v_mfma_f32_32x32x16_bf16 v[64:79], v[112:115], v[48:51], v[64:79]
    ds_read_b128 v[104:107], v3 offset:43008
    ds_read_b128 v[108:111], v3 offset:44032
    v_exp_f32 v32, v32
    v_exp_f32 v33, v33
    v_exp_f32 v34, v34
    v_mfma_f32_32x32x16_bf16 v[64:79], v[116:119], v[52:55], v[64:79]
    ds_read_b128 v[88:91], v3 offset:49152
    ds_read_b128 v[92:95], v3 offset:50176
    v_exp_f32 v35, v35
    v_cvt_pk_bf16_f32 v32, v32, v33
    v_exp_f32 v36, v36
    v_cvt_pk_bf16_f32 v33, v34, v35
    v_mfma_f32_16x16x32_bf16 v[80:83], v[84:87], v[48:51], v[80:83]
    v_exp_f32 v37, v37
    v_mfma_f32_16x16x32_bf16 v[80:83], v[84:87], v[52:55], v[80:83]
    v_exp_f32 v38, v38
    v_mfma_f32_32x32x16_bf16 v[48:63], v[96:99], v[8:11], v[16:31]
    v_cvt_pk_bf16_f32 v34, v36, v37
    v_exp_f32 v39, v39
    v_exp_f32 v40, v40
    v_cvt_pk_bf16_f32 v35, v38, v39
    v_mfma_f32_32x32x16_bf16 v[48:63], v[100:103], v[12:15], v[48:63]
    v_exp_f32 v41, v41
    v_exp_f32 v42, v42
    v_cvt_pk_bf16_f32 v36, v40, v41
    v_exp_f32 v43, v43
    v_exp_f32 v44, v44
    v_cvt_pk_bf16_f32 v37, v42, v43
    v_exp_f32 v45, v45
    v_exp_f32 v46, v46
    v_exp_f32 v47, v47
    v_cvt_pk_bf16_f32 v38, v44, v45
    v_cvt_pk_bf16_f32 v39, v46, v47
    s_waitcnt lgkmcnt(0)
    v_mfma_f32_32x32x16_bf16 v[64:79], v[104:107], v[32:35], v[64:79]
    ds_read_b128 v[112:115], v3 offset:47104
    ds_read_b128 v[116:119], v3 offset:48128
    v_exp_f32 v48, v48
    v_exp_f32 v49, v49
    v_exp_f32 v50, v50
    v_mfma_f32_32x32x16_bf16 v[64:79], v[108:111], v[36:39], v[64:79]
    ds_read_b128 v[96:99], v3 offset:53248
    ds_read_b128 v[100:103], v3 offset:54272
    v_exp_f32 v51, v51
    v_cvt_pk_bf16_f32 v48, v48, v49
    v_exp_f32 v52, v52
    v_cvt_pk_bf16_f32 v49, v50, v51
    v_mfma_f32_16x16x32_bf16 v[80:83], v[84:87], v[32:35], v[80:83]
    v_exp_f32 v53, v53
    v_mfma_f32_16x16x32_bf16 v[80:83], v[84:87], v[36:39], v[80:83]
    v_exp_f32 v54, v54
    v_mfma_f32_32x32x16_bf16 v[32:47], v[88:91], v[8:11], v[16:31]
    v_cvt_pk_bf16_f32 v50, v52, v53
    v_exp_f32 v55, v55
    v_exp_f32 v56, v56
    v_cvt_pk_bf16_f32 v51, v54, v55
    v_mfma_f32_32x32x16_bf16 v[32:47], v[92:95], v[12:15], v[32:47]
    v_exp_f32 v57, v57
    v_exp_f32 v58, v58
    v_cvt_pk_bf16_f32 v52, v56, v57
    v_exp_f32 v59, v59
    v_exp_f32 v60, v60
    v_cvt_pk_bf16_f32 v53, v58, v59
    v_exp_f32 v61, v61
    v_exp_f32 v62, v62
    v_exp_f32 v63, v63
    v_cvt_pk_bf16_f32 v54, v60, v61
    v_cvt_pk_bf16_f32 v55, v62, v63
    s_waitcnt lgkmcnt(0)
    v_mfma_f32_32x32x16_bf16 v[64:79], v[112:115], v[48:51], v[64:79]
    ds_read_b128 v[104:107], v3 offset:51200
    ds_read_b128 v[108:111], v3 offset:52224
    v_exp_f32 v32, v32
    v_exp_f32 v33, v33
    v_exp_f32 v34, v34
    v_mfma_f32_32x32x16_bf16 v[64:79], v[116:119], v[52:55], v[64:79]
    ds_read_b128 v[88:91], v3 offset:57344
    ds_read_b128 v[92:95], v3 offset:58368
    v_exp_f32 v35, v35
    v_cvt_pk_bf16_f32 v32, v32, v33
    v_exp_f32 v36, v36
    v_cvt_pk_bf16_f32 v33, v34, v35
    v_mfma_f32_16x16x32_bf16 v[80:83], v[84:87], v[48:51], v[80:83]
    v_exp_f32 v37, v37
    v_mfma_f32_16x16x32_bf16 v[80:83], v[84:87], v[52:55], v[80:83]
    v_exp_f32 v38, v38
    v_mfma_f32_32x32x16_bf16 v[48:63], v[96:99], v[8:11], v[16:31]
    v_cvt_pk_bf16_f32 v34, v36, v37
    v_exp_f32 v39, v39
    v_exp_f32 v40, v40
    v_cvt_pk_bf16_f32 v35, v38, v39
    v_mfma_f32_32x32x16_bf16 v[48:63], v[100:103], v[12:15], v[48:63]
    v_exp_f32 v41, v41
    v_exp_f32 v42, v42
    v_cvt_pk_bf16_f32 v36, v40, v41
    v_exp_f32 v43, v43
    v_exp_f32 v44, v44
    v_cvt_pk_bf16_f32 v37, v42, v43
    v_exp_f32 v45, v45
    v_exp_f32 v46, v46
    v_exp_f32 v47, v47
    v_cvt_pk_bf16_f32 v38, v44, v45
    v_cvt_pk_bf16_f32 v39, v46, v47
    s_waitcnt lgkmcnt(0)
    v_mfma_f32_32x32x16_bf16 v[64:79], v[104:107], v[32:35], v[64:79]
    ds_read_b128 v[112:115], v3 offset:55296
    ds_read_b128 v[116:119], v3 offset:56320
    v_exp_f32 v48, v48
    v_exp_f32 v49, v49
    v_exp_f32 v50, v50
    v_mfma_f32_32x32x16_bf16 v[64:79], v[108:111], v[36:39], v[64:79]
    ds_read_b128 v[96:99], v3 offset:61440
    ds_read_b128 v[100:103], v3 offset:62464
    v_exp_f32 v51, v51
    v_cvt_pk_bf16_f32 v48, v48, v49
    v_exp_f32 v52, v52
    v_cvt_pk_bf16_f32 v49, v50, v51
    v_mfma_f32_16x16x32_bf16 v[80:83], v[84:87], v[32:35], v[80:83]
    v_exp_f32 v53, v53
    v_mfma_f32_16x16x32_bf16 v[80:83], v[84:87], v[36:39], v[80:83]
    v_exp_f32 v54, v54
    v_mfma_f32_32x32x16_bf16 v[32:47], v[88:91], v[8:11], v[16:31]
    v_cvt_pk_bf16_f32 v50, v52, v53
    v_exp_f32 v55, v55
    v_exp_f32 v56, v56
    v_cvt_pk_bf16_f32 v51, v54, v55
    v_mfma_f32_32x32x16_bf16 v[32:47], v[92:95], v[12:15], v[32:47]
    v_exp_f32 v57, v57
    v_exp_f32 v58, v58
    v_cvt_pk_bf16_f32 v52, v56, v57
    v_exp_f32 v59, v59
    v_exp_f32 v60, v60
    v_cvt_pk_bf16_f32 v53, v58, v59
    v_exp_f32 v61, v61
    v_exp_f32 v62, v62
    v_exp_f32 v63, v63
    v_cvt_pk_bf16_f32 v54, v60, v61
    v_cvt_pk_bf16_f32 v55, v62, v63
    s_waitcnt vmcnt(0) lgkmcnt(0)
    s_barrier
    v_mfma_f32_32x32x16_bf16 v[64:79], v[112:115], v[48:51], v[64:79]
    ds_read_b128 v[104:107], v3 offset:59392
    ds_read_b128 v[108:111], v3 offset:60416
    v_exp_f32 v32, v32
    v_exp_f32 v33, v33
    v_exp_f32 v34, v34
    v_mfma_f32_32x32x16_bf16 v[64:79], v[116:119], v[52:55], v[64:79]
    ds_read_b128 v[88:91], v4 offset:0
    ds_read_b128 v[92:95], v4 offset:1024
    v_exp_f32 v35, v35
    v_cvt_pk_bf16_f32 v32, v32, v33
    v_exp_f32 v36, v36
    v_cvt_pk_bf16_f32 v33, v34, v35
    v_mfma_f32_16x16x32_bf16 v[80:83], v[84:87], v[48:51], v[80:83]
    v_exp_f32 v37, v37
    v_mfma_f32_16x16x32_bf16 v[80:83], v[84:87], v[52:55], v[80:83]
    v_exp_f32 v38, v38
    v_mfma_f32_32x32x16_bf16 v[48:63], v[96:99], v[8:11], v[16:31]
    v_cvt_pk_bf16_f32 v34, v36, v37
    v_exp_f32 v39, v39
    v_exp_f32 v40, v40
    v_cvt_pk_bf16_f32 v35, v38, v39
    v_mfma_f32_32x32x16_bf16 v[48:63], v[100:103], v[12:15], v[48:63]
    v_exp_f32 v41, v41
    v_exp_f32 v42, v42
    v_cvt_pk_bf16_f32 v36, v40, v41
    v_exp_f32 v43, v43
    v_exp_f32 v44, v44
    v_cvt_pk_bf16_f32 v37, v42, v43
    v_exp_f32 v45, v45
    v_exp_f32 v46, v46
    v_exp_f32 v47, v47
    v_cvt_pk_bf16_f32 v38, v44, v45
    v_cvt_pk_bf16_f32 v39, v46, v47
    s_waitcnt lgkmcnt(0)
    v_mfma_f32_32x32x16_bf16 v[64:79], v[104:107], v[32:35], v[64:79]
    ds_read_b128 v[112:115], v3 offset:63488
    ds_read_b128 v[116:119], v3 offset:64512
    v_exp_f32 v48, v48
    v_exp_f32 v49, v49
    v_exp_f32 v50, v50
    v_mfma_f32_32x32x16_bf16 v[64:79], v[108:111], v[36:39], v[64:79]
    ds_read_b128 v[96:99], v4 offset:4096
    ds_read_b128 v[100:103], v4 offset:5120
    v_exp_f32 v51, v51
    v_cvt_pk_bf16_f32 v48, v48, v49
    v_exp_f32 v52, v52
    v_cvt_pk_bf16_f32 v49, v50, v51
    v_mfma_f32_16x16x32_bf16 v[80:83], v[84:87], v[32:35], v[80:83]
    v_exp_f32 v53, v53
    v_mfma_f32_16x16x32_bf16 v[80:83], v[84:87], v[36:39], v[80:83]
    v_exp_f32 v54, v54
    v_mfma_f32_32x32x16_bf16 v[32:47], v[88:91], v[8:11], v[16:31]
    v_cvt_pk_bf16_f32 v50, v52, v53
    v_exp_f32 v55, v55
    v_exp_f32 v56, v56
    v_cvt_pk_bf16_f32 v51, v54, v55
    v_mfma_f32_32x32x16_bf16 v[32:47], v[92:95], v[12:15], v[32:47]
    v_exp_f32 v57, v57
    v_exp_f32 v58, v58
    v_cvt_pk_bf16_f32 v52, v56, v57
    v_exp_f32 v59, v59
    v_exp_f32 v60, v60
    v_cvt_pk_bf16_f32 v53, v58, v59
    v_exp_f32 v61, v61
    v_exp_f32 v62, v62
    v_exp_f32 v63, v63
    v_cvt_pk_bf16_f32 v54, v60, v61
    v_cvt_pk_bf16_f32 v55, v62, v63
    s_waitcnt lgkmcnt(0)
    v_mfma_f32_32x32x16_bf16 v[64:79], v[112:115], v[48:51], v[64:79]
    ds_read_b128 v[104:107], v4 offset:2048
    ds_read_b128 v[108:111], v4 offset:3072
    v_exp_f32 v32, v32
    v_exp_f32 v33, v33
    v_exp_f32 v34, v34
    v_mfma_f32_32x32x16_bf16 v[64:79], v[116:119], v[52:55], v[64:79]
    ds_read_b128 v[88:91], v4 offset:8192
    ds_read_b128 v[92:95], v4 offset:9216
    v_exp_f32 v35, v35
    v_cvt_pk_bf16_f32 v32, v32, v33
    v_exp_f32 v36, v36
    v_cvt_pk_bf16_f32 v33, v34, v35
    v_mfma_f32_16x16x32_bf16 v[80:83], v[84:87], v[48:51], v[80:83]
    v_exp_f32 v37, v37
    v_mfma_f32_16x16x32_bf16 v[80:83], v[84:87], v[52:55], v[80:83]
    v_exp_f32 v38, v38
    v_mfma_f32_32x32x16_bf16 v[48:63], v[96:99], v[8:11], v[16:31]
    v_cvt_pk_bf16_f32 v34, v36, v37
    v_exp_f32 v39, v39
    v_exp_f32 v40, v40
    v_cvt_pk_bf16_f32 v35, v38, v39
    v_mfma_f32_32x32x16_bf16 v[48:63], v[100:103], v[12:15], v[48:63]
    v_exp_f32 v41, v41
    v_exp_f32 v42, v42
    v_cvt_pk_bf16_f32 v36, v40, v41
    v_exp_f32 v43, v43
    v_exp_f32 v44, v44
    v_cvt_pk_bf16_f32 v37, v42, v43
    v_exp_f32 v45, v45
    v_exp_f32 v46, v46
    v_exp_f32 v47, v47
    v_cvt_pk_bf16_f32 v38, v44, v45
    v_cvt_pk_bf16_f32 v39, v46, v47
    s_waitcnt lgkmcnt(0)
    v_mfma_f32_32x32x16_bf16 v[64:79], v[104:107], v[32:35], v[64:79]
    ds_read_b128 v[112:115], v4 offset:6144
    ds_read_b128 v[116:119], v4 offset:7168
    v_exp_f32 v48, v48
    v_exp_f32 v49, v49
    v_exp_f32 v50, v50
    v_mfma_f32_32x32x16_bf16 v[64:79], v[108:111], v[36:39], v[64:79]
    ds_read_b128 v[96:99], v4 offset:12288
    ds_read_b128 v[100:103], v4 offset:13312
    v_exp_f32 v51, v51
    v_cvt_pk_bf16_f32 v48, v48, v49
    v_exp_f32 v52, v52
    v_cvt_pk_bf16_f32 v49, v50, v51
    v_mfma_f32_16x16x32_bf16 v[80:83], v[84:87], v[32:35], v[80:83]
    v_exp_f32 v53, v53
    v_mfma_f32_16x16x32_bf16 v[80:83], v[84:87], v[36:39], v[80:83]
    v_exp_f32 v54, v54
    v_mfma_f32_32x32x16_bf16 v[32:47], v[88:91], v[8:11], v[16:31]
    v_cvt_pk_bf16_f32 v50, v52, v53
    v_exp_f32 v55, v55
    v_exp_f32 v56, v56
    v_cvt_pk_bf16_f32 v51, v54, v55
    v_mfma_f32_32x32x16_bf16 v[32:47], v[92:95], v[12:15], v[32:47]
    v_exp_f32 v57, v57
    v_exp_f32 v58, v58
    v_cvt_pk_bf16_f32 v52, v56, v57
    v_exp_f32 v59, v59
    v_exp_f32 v60, v60
    v_cvt_pk_bf16_f32 v53, v58, v59
    v_exp_f32 v61, v61
    v_exp_f32 v62, v62
    v_exp_f32 v63, v63
    v_cvt_pk_bf16_f32 v54, v60, v61
    v_cvt_pk_bf16_f32 v55, v62, v63
    s_waitcnt lgkmcnt(0)
    v_mfma_f32_32x32x16_bf16 v[64:79], v[112:115], v[48:51], v[64:79]
    ds_read_b128 v[104:107], v4 offset:10240
    ds_read_b128 v[108:111], v4 offset:11264
    v_exp_f32 v32, v32
    v_exp_f32 v33, v33
    v_exp_f32 v34, v34
    v_mfma_f32_32x32x16_bf16 v[64:79], v[116:119], v[52:55], v[64:79]
    ds_read_b128 v[88:91], v3 offset:0
    ds_read_b128 v[92:95], v3 offset:1024
    v_exp_f32 v35, v35
    v_cvt_pk_bf16_f32 v32, v32, v33
    v_exp_f32 v36, v36
    v_cvt_pk_bf16_f32 v33, v34, v35
    v_mfma_f32_16x16x32_bf16 v[80:83], v[84:87], v[48:51], v[80:83]
    v_exp_f32 v37, v37
    v_mfma_f32_16x16x32_bf16 v[80:83], v[84:87], v[52:55], v[80:83]
    v_exp_f32 v38, v38
    v_mfma_f32_32x32x16_bf16 v[48:63], v[96:99], v[8:11], v[16:31]
    v_cvt_pk_bf16_f32 v34, v36, v37
    v_exp_f32 v39, v39
    v_exp_f32 v40, v40
    v_cvt_pk_bf16_f32 v35, v38, v39
    v_mfma_f32_32x32x16_bf16 v[48:63], v[100:103], v[12:15], v[48:63]
    v_exp_f32 v41, v41
    v_exp_f32 v42, v42
    v_cvt_pk_bf16_f32 v36, v40, v41
    v_exp_f32 v43, v43
    v_exp_f32 v44, v44
    v_cvt_pk_bf16_f32 v37, v42, v43
    v_exp_f32 v45, v45
    v_exp_f32 v46, v46
    v_exp_f32 v47, v47
    v_cvt_pk_bf16_f32 v38, v44, v45
    v_cvt_pk_bf16_f32 v39, v46, v47
    s_waitcnt lgkmcnt(0)
    v_mfma_f32_32x32x16_bf16 v[64:79], v[104:107], v[32:35], v[64:79]
    ds_read_b128 v[112:115], v4 offset:14336
    ds_read_b128 v[116:119], v4 offset:15360
    v_exp_f32 v48, v48
    v_exp_f32 v49, v49
    v_exp_f32 v50, v50
    v_mfma_f32_32x32x16_bf16 v[64:79], v[108:111], v[36:39], v[64:79]
    ds_read_b128 v[96:99], v3 offset:4096
    ds_read_b128 v[100:103], v3 offset:5120
    v_exp_f32 v51, v51
    v_cvt_pk_bf16_f32 v48, v48, v49
    v_exp_f32 v52, v52
    v_cvt_pk_bf16_f32 v49, v50, v51
    v_mfma_f32_16x16x32_bf16 v[80:83], v[84:87], v[32:35], v[80:83]
    v_exp_f32 v53, v53
    v_mfma_f32_16x16x32_bf16 v[80:83], v[84:87], v[36:39], v[80:83]
    v_exp_f32 v54, v54
    v_mfma_f32_32x32x16_bf16 v[32:47], v[88:91], v[8:11], v[16:31]
    v_cvt_pk_bf16_f32 v50, v52, v53
    v_exp_f32 v55, v55
    v_exp_f32 v56, v56
    v_cvt_pk_bf16_f32 v51, v54, v55
    v_mfma_f32_32x32x16_bf16 v[32:47], v[92:95], v[12:15], v[32:47]
    v_exp_f32 v57, v57
    v_exp_f32 v58, v58
    v_cvt_pk_bf16_f32 v52, v56, v57
    v_exp_f32 v59, v59
    v_exp_f32 v60, v60
    v_cvt_pk_bf16_f32 v53, v58, v59
    v_exp_f32 v61, v61
    v_exp_f32 v62, v62
    v_exp_f32 v63, v63
    v_cvt_pk_bf16_f32 v54, v60, v61
    v_cvt_pk_bf16_f32 v55, v62, v63
    s_waitcnt lgkmcnt(0)
    v_mfma_f32_32x32x16_bf16 v[64:79], v[112:115], v[48:51], v[64:79]
    ds_read_b128 v[104:107], v3 offset:2048
    ds_read_b128 v[108:111], v3 offset:3072
    v_exp_f32 v32, v32
    v_exp_f32 v33, v33
    v_exp_f32 v34, v34
    v_mfma_f32_32x32x16_bf16 v[64:79], v[116:119], v[52:55], v[64:79]
    ds_read_b128 v[88:91], v3 offset:8192
    ds_read_b128 v[92:95], v3 offset:9216
    v_exp_f32 v35, v35
    v_cvt_pk_bf16_f32 v32, v32, v33
    v_exp_f32 v36, v36
    v_cvt_pk_bf16_f32 v33, v34, v35
    v_mfma_f32_16x16x32_bf16 v[80:83], v[84:87], v[48:51], v[80:83]
    v_exp_f32 v37, v37
    v_mfma_f32_16x16x32_bf16 v[80:83], v[84:87], v[52:55], v[80:83]
    v_exp_f32 v38, v38
    v_mfma_f32_32x32x16_bf16 v[48:63], v[96:99], v[8:11], v[16:31]
    v_cvt_pk_bf16_f32 v34, v36, v37
    v_exp_f32 v39, v39
    v_exp_f32 v40, v40
    v_cvt_pk_bf16_f32 v35, v38, v39
    v_mfma_f32_32x32x16_bf16 v[48:63], v[100:103], v[12:15], v[48:63]
    v_exp_f32 v41, v41
    v_exp_f32 v42, v42
    v_cvt_pk_bf16_f32 v36, v40, v41
    v_exp_f32 v43, v43
    v_exp_f32 v44, v44
    v_cvt_pk_bf16_f32 v37, v42, v43
    v_exp_f32 v45, v45
    v_exp_f32 v46, v46
    v_exp_f32 v47, v47
    v_cvt_pk_bf16_f32 v38, v44, v45
    v_cvt_pk_bf16_f32 v39, v46, v47
    s_waitcnt lgkmcnt(0)
    v_mfma_f32_32x32x16_bf16 v[64:79], v[104:107], v[32:35], v[64:79]
    ds_read_b128 v[112:115], v3 offset:6144
    ds_read_b128 v[116:119], v3 offset:7168
    v_exp_f32 v48, v48
    v_exp_f32 v49, v49
    v_exp_f32 v50, v50
    v_mfma_f32_32x32x16_bf16 v[64:79], v[108:111], v[36:39], v[64:79]
    ds_read_b128 v[96:99], v3 offset:12288
    ds_read_b128 v[100:103], v3 offset:13312
    v_exp_f32 v51, v51
    v_cvt_pk_bf16_f32 v48, v48, v49
    v_exp_f32 v52, v52
    v_cvt_pk_bf16_f32 v49, v50, v51
    v_mfma_f32_16x16x32_bf16 v[80:83], v[84:87], v[32:35], v[80:83]
    v_exp_f32 v53, v53
    v_mfma_f32_16x16x32_bf16 v[80:83], v[84:87], v[36:39], v[80:83]
    v_exp_f32 v54, v54
    v_mfma_f32_32x32x16_bf16 v[32:47], v[88:91], v[8:11], v[16:31]
    v_cvt_pk_bf16_f32 v50, v52, v53
    v_exp_f32 v55, v55
    v_exp_f32 v56, v56
    v_cvt_pk_bf16_f32 v51, v54, v55
    v_mfma_f32_32x32x16_bf16 v[32:47], v[92:95], v[12:15], v[32:47]
    v_exp_f32 v57, v57
    v_exp_f32 v58, v58
    v_cvt_pk_bf16_f32 v52, v56, v57
    v_exp_f32 v59, v59
    v_exp_f32 v60, v60
    v_cvt_pk_bf16_f32 v53, v58, v59
    v_exp_f32 v61, v61
    v_exp_f32 v62, v62
    v_exp_f32 v63, v63
    v_cvt_pk_bf16_f32 v54, v60, v61
    v_cvt_pk_bf16_f32 v55, v62, v63
    s_waitcnt lgkmcnt(0)
    v_mfma_f32_32x32x16_bf16 v[64:79], v[112:115], v[48:51], v[64:79]
    ds_read_b128 v[104:107], v3 offset:10240
    ds_read_b128 v[108:111], v3 offset:11264
    v_exp_f32 v32, v32
    v_exp_f32 v33, v33
    v_exp_f32 v34, v34
    v_mfma_f32_32x32x16_bf16 v[64:79], v[116:119], v[52:55], v[64:79]
    v_exp_f32 v35, v35
    v_cvt_pk_bf16_f32 v32, v32, v33
    v_exp_f32 v36, v36
    v_cvt_pk_bf16_f32 v33, v34, v35
    v_mfma_f32_16x16x32_bf16 v[80:83], v[84:87], v[48:51], v[80:83]
    v_exp_f32 v37, v37
    v_mfma_f32_16x16x32_bf16 v[80:83], v[84:87], v[52:55], v[80:83]
    v_exp_f32 v38, v38
    v_mfma_f32_32x32x16_bf16 v[48:63], v[96:99], v[8:11], v[16:31]
    v_cvt_pk_bf16_f32 v34, v36, v37
    v_exp_f32 v39, v39
    v_exp_f32 v40, v40
    v_cvt_pk_bf16_f32 v35, v38, v39
    v_mfma_f32_32x32x16_bf16 v[48:63], v[100:103], v[12:15], v[48:63]
    v_exp_f32 v41, v41
    v_exp_f32 v42, v42
    v_cvt_pk_bf16_f32 v36, v40, v41
    v_exp_f32 v43, v43
    v_exp_f32 v44, v44
    v_cvt_pk_bf16_f32 v37, v42, v43
    v_exp_f32 v45, v45
    v_exp_f32 v46, v46
    v_exp_f32 v47, v47
    v_cvt_pk_bf16_f32 v38, v44, v45
    v_cvt_pk_bf16_f32 v39, v46, v47
    s_waitcnt lgkmcnt(0)
    v_mfma_f32_32x32x16_bf16 v[64:79], v[104:107], v[32:35], v[64:79]
    ds_read_b128 v[112:115], v3 offset:14336
    ds_read_b128 v[116:119], v3 offset:15360
    v_exp_f32 v48, v48
    v_exp_f32 v49, v49
    v_exp_f32 v50, v50
    v_mfma_f32_32x32x16_bf16 v[64:79], v[108:111], v[36:39], v[64:79]
    v_exp_f32 v51, v51
    v_cvt_pk_bf16_f32 v48, v48, v49
    v_exp_f32 v52, v52
    v_cvt_pk_bf16_f32 v49, v50, v51
    v_mfma_f32_16x16x32_bf16 v[80:83], v[84:87], v[32:35], v[80:83]
    v_exp_f32 v53, v53
    v_mfma_f32_16x16x32_bf16 v[80:83], v[84:87], v[36:39], v[80:83]
    v_exp_f32 v54, v54
    v_cvt_pk_bf16_f32 v50, v52, v53
    v_exp_f32 v55, v55
    v_exp_f32 v56, v56
    v_cvt_pk_bf16_f32 v51, v54, v55
    v_exp_f32 v57, v57
    v_exp_f32 v58, v58
    v_cvt_pk_bf16_f32 v52, v56, v57
    v_exp_f32 v59, v59
    v_exp_f32 v60, v60
    v_cvt_pk_bf16_f32 v53, v58, v59
    v_exp_f32 v61, v61
    v_exp_f32 v62, v62
    v_exp_f32 v63, v63
    v_cvt_pk_bf16_f32 v54, v60, v61
    v_cvt_pk_bf16_f32 v55, v62, v63
    s_waitcnt lgkmcnt(0)
    v_mfma_f32_32x32x16_bf16 v[64:79], v[112:115], v[48:51], v[64:79]
    v_mfma_f32_16x16x32_bf16 v[80:83], v[84:87], v[48:51], v[80:83]
    v_mfma_f32_32x32x16_bf16 v[64:79], v[116:119], v[52:55], v[64:79]
    v_mfma_f32_16x16x32_bf16 v[80:83], v[84:87], v[52:55], v[80:83]
    s_nop 15
    s_nop 3
    v_mul_f32 v6, 0, v80
    v_fmac_f32 v6, 0, v64
    v_fmac_f32 v6, 0, v65
    v_fmac_f32 v6, 0, v66
    v_fmac_f32 v6, 0, v67
    v_fmac_f32 v6, 0, v68
    v_fmac_f32 v6, 0, v69
    v_fmac_f32 v6, 0, v70
    v_fmac_f32 v6, 0, v71
    v_fmac_f32 v6, 0, v72
    v_fmac_f32 v6, 0, v73
    v_fmac_f32 v6, 0, v74
    v_fmac_f32 v6, 0, v75
    v_fmac_f32 v6, 0, v76
    v_fmac_f32 v6, 0, v77
    v_fmac_f32 v6, 0, v78
    v_fmac_f32 v6, 0, v79
    v_cmp_neq_f32 vcc, 0, v6
    s_cmp_lg_u64 vcc, 0
    s_cbranch_scc1 K2_SLOW
K2_FIN:
    v_rcp_f32 v6, v80
    s_nop 0
    v_mul_f32 v64, v64, v6
    v_mul_f32 v65, v65, v6
    v_mul_f32 v66, v66, v6
    v_mul_f32 v67, v67, v6
    v_mul_f32 v68, v68, v6
    v_mul_f32 v69, v69, v6
    v_mul_f32 v70, v70, v6
    v_mul_f32 v71, v71, v6
    v_mul_f32 v72, v72, v6
    v_mul_f32 v73, v73, v6
    v_mul_f32 v74, v74, v6
    v_mul_f32 v75, v75, v6
    v_mul_f32 v76, v76, v6
    v_mul_f32 v77, v77, v6
    v_mul_f32 v78, v78, v6
    v_mul_f32 v79, v79, v6
    v_cvt_pk_bf16_f32 v64, v64, v65
    v_cvt_pk_bf16_f32 v65, v66, v67
    v_cvt_pk_bf16_f32 v66, v68, v69
    v_cvt_pk_bf16_f32 v67, v70, v71
    v_cvt_pk_bf16_f32 v68, v72, v73
    v_cvt_pk_bf16_f32 v69, v74, v75
    v_cvt_pk_bf16_f32 v70, v76, v77
    v_cvt_pk_bf16_f32 v71, v78, v79
    s_lshl_b32 s35, s26, 3
    s_add_u32 s35, s35, s24
    s_lshl_b32 s35, s35, 16
    s_lshl_b32 s36, s25, 11
    s_add_u32 s35, s35, s36
    s_add_u32 s35, s35, 0xc00000
    buffer_store_dwordx4 v[64:67], v3, s[20:23], s35 offen sc1
    buffer_store_dwordx4 v[68:71], v3, s[20:23], s35 offen offset:1024 sc1
    s_lshl_b32 s40, s26, 3
    s_add_u32 s40, s40, s24
    s_lshl_b32 s40, s40, 7
    s_lshl_b32 s41, s25, 2
    s_add_u32 s40, s40, s41
    s_add_u32 s40, s40, 0x2000000
    s_waitcnt vmcnt(0)
    v_mov_b32 v6, 1
    v_mov_b32 v7, 0
    s_mov_b64 exec, 1
    buffer_store_dword v6, v7, s[20:23], s40 offen sc1
    s_mov_b64 exec, -1
    s_endpgm
K2_SLOW:
    s_add_u32 s40, s30, 0x400000
    s_mov_b32 s41, 0
    v_mov_b32 v6, 0xff800000
K2_SLOW1:
    buffer_load_dwordx4 v[88:91], v3, s[20:23], s40 offen
    buffer_load_dwordx4 v[92:95], v3, s[20:23], s40 offen offset:1024
    s_waitcnt vmcnt(0)
    v_mfma_f32_32x32x16_bf16 v[32:47], v[88:91], v[8:11], 0
    v_mfma_f32_32x32x16_bf16 v[32:47], v[92:95], v[12:15], v[32:47]
    s_nop 15
    s_nop 3
    v_max3_f32 v6, v6, v32, v33
    v_max3_f32 v6, v6, v34, v35
    v_max3_f32 v6, v6, v36, v37
    v_max3_f32 v6, v6, v38, v39
    v_max3_f32 v6, v6, v40, v41
    v_max3_f32 v6, v6, v42, v43
    v_max3_f32 v6, v6, v44, v45
    v_max3_f32 v6, v6, v46, v47
    s_add_u32 s40, s40, 4096
    s_add_u32 s41, s41, 1
    s_cmp_lt_u32 s41, 64
    s_cbranch_scc1 K2_SLOW1
    v_mov_b32 v7, v6
    s_nop 1
    v_permlane32_swap_b32 v6, v7
    s_nop 1
    v_max_f32 v6, v6, v7
    v_sub_f32 v6, 0, v6
    v_mov_b32 v16, v6
    v_mov_b32 v64, 0
    v_mov_b32 v17, v6
    v_mov_b32 v65, 0
    v_mov_b32 v18, v6
    v_mov_b32 v66, 0
    v_mov_b32 v19, v6
    v_mov_b32 v67, 0
    v_mov_b32 v20, v6
    v_mov_b32 v68, 0
    v_mov_b32 v21, v6
    v_mov_b32 v69, 0
    v_mov_b32 v22, v6
    v_mov_b32 v70, 0
    v_mov_b32 v23, v6
    v_mov_b32 v71, 0
    v_mov_b32 v24, v6
    v_mov_b32 v72, 0
    v_mov_b32 v25, v6
    v_mov_b32 v73, 0
    v_mov_b32 v26, v6
    v_mov_b32 v74, 0
    v_mov_b32 v27, v6
    v_mov_b32 v75, 0
    v_mov_b32 v28, v6
    v_mov_b32 v76, 0
    v_mov_b32 v29, v6
    v_mov_b32 v77, 0
    v_mov_b32 v30, v6
    v_mov_b32 v78, 0
    v_mov_b32 v31, v6
    v_mov_b32 v79, 0
    v_mov_b32 v80, 0
    v_mov_b32 v81, 0
    v_mov_b32 v82, 0
    v_mov_b32 v83, 0
    s_add_u32 s40, s30, 0x400000
    s_mov_b32 s41, 0
K2_SLOW2:
    s_add_u32 s42, s40, 2048
    buffer_load_dwordx4 v[88:91], v3, s[20:23], s40 offen
    buffer_load_dwordx4 v[92:95], v3, s[20:23], s40 offen offset:1024
    buffer_load_dwordx4 v[104:107], v3, s[20:23], s42 offen
    buffer_load_dwordx4 v[108:111], v3, s[20:23], s42 offen offset:1024
    s_waitcnt vmcnt(0)
    v_mfma_f32_32x32x16_bf16 v[32:47], v[88:91], v[8:11], v[16:31]
    v_mfma_f32_32x32x16_bf16 v[32:47], v[92:95], v[12:15], v[32:47]
    s_nop 15
    s_nop 3
    v_exp_f32 v32, v32
    v_exp_f32 v33, v33
    v_exp_f32 v34, v34
    v_exp_f32 v35, v35
    v_exp_f32 v36, v36
    v_exp_f32 v37, v37
    v_exp_f32 v38, v38
    v_exp_f32 v39, v39
    v_exp_f32 v40, v40
    v_exp_f32 v41, v41
    v_exp_f32 v42, v42
    v_exp_f32 v43, v43
    v_exp_f32 v44, v44
    v_exp_f32 v45, v45
    v_exp_f32 v46, v46
    v_exp_f32 v47, v47
    s_nop 0
    v_cvt_pk_bf16_f32 v32, v32, v33
    v_cvt_pk_bf16_f32 v33, v34, v35
    v_cvt_pk_bf16_f32 v34, v36, v37
    v_cvt_pk_bf16_f32 v35, v38, v39
    v_cvt_pk_bf16_f32 v36, v40, v41
    v_cvt_pk_bf16_f32 v37, v42, v43
    v_cvt_pk_bf16_f32 v38, v44, v45
    v_cvt_pk_bf16_f32 v39, v46, v47
    s_nop 1
    v_mfma_f32_32x32x16_bf16 v[64:79], v[104:107], v[32:35], v[64:79]
    v_mfma_f32_16x16x32_bf16 v[80:83], v[84:87], v[32:35], v[80:83]
    v_mfma_f32_32x32x16_bf16 v[64:79], v[108:111], v[36:39], v[64:79]
    v_mfma_f32_16x16x32_bf16 v[80:83], v[84:87], v[36:39], v[80:83]
    s_add_u32 s40, s40, 4096
    s_add_u32 s41, s41, 1
    s_cmp_lt_u32 s41, 64
    s_cbranch_scc1 K2_SLOW2
    s_nop 15
    s_nop 3
    s_branch K2_FIN
K2_P1:
    s_load_dwordx4 s[4:7], s[0:1], 24
    s_load_dwordx2 s[10:11], s[0:1], 40
    s_load_dwordx2 s[44:45], s[0:1], 16
    s_sub_u32 s25, s2, 256
    s_and_b32 s28, s25, 7
    s_lshr_b32 s29, s25, 3
    s_and_b32 s26, s29, 7
    s_lshr_b32 s29, s29, 3
    s_lshl_b32 s28, s28, 2
    s_add_u32 s27, s28, s29
    v_lshrrev_b32 v3, 2, v2
    v_lshlrev_b32 v3, 16, v3
    v_and_b32 v4, 3, v2
    v_lshlrev_b32 v4, 4, v4
    v_add_u32 v3, v3, v4
    v_and_b32 v5, 7, v2
    s_lshl_b32 s30, s26, 3
    v_add_u32 v5, s30, v5
    v_lshlrev_b32 v5, 17, v5
    v_lshrrev_b32 v6, 4, v2
    v_lshlrev_b32 v6, 4, v6
    v_add_u32 v5, v5, v6
    s_add_u32 s31, s30, s24
    v_and_b32 v6, 15, v2
    v_lshlrev_b32 v6, 6, v6
    v_add_u32 v6, s31, v6
    v_lshlrev_b32 v6, 12, v6
    v_lshrrev_b32 v7, 5, v2
    v_lshlrev_b32 v8, 4, v7
    v_add_u32 v9, v6, v8
    s_waitcnt lgkmcnt(0)
    s_mov_b32 s12, s4
    s_mov_b32 s13, s5
    s_mov_b32 s14, 0x400000
    s_mov_b32 s15, 0x20000
    s_mov_b32 s16, s6
    s_mov_b32 s17, s7
    s_mov_b32 s18, 0x800000
    s_mov_b32 s19, 0x20000
    s_mov_b32 s20, s8
    s_mov_b32 s21, s9
    s_mov_b32 s22, 0x4000000
    s_mov_b32 s23, 0x20000
    s_mov_b32 s36, s10
    s_mov_b32 s37, s11
    s_mov_b32 s38, 0x800000
    s_mov_b32 s39, 0x20000
    s_lshl_b32 s32, s24, 13
    s_lshl_b32 s33, s27, 6
    s_add_u32 s32, s32, s33
    s_add_u32 s33, s32, 0x0
    buffer_load_dwordx4 v[32:35], v3, s[12:15], s33 offen
    s_add_u32 s33, s32, 0x100000
    buffer_load_dwordx4 v[36:39], v3, s[12:15], s33 offen
    s_add_u32 s33, s32, 0x200000
    buffer_load_dwordx4 v[40:43], v3, s[12:15], s33 offen
    s_add_u32 s33, s32, 0x300000
    buffer_load_dwordx4 v[44:47], v3, s[12:15], s33 offen
    s_add_u32 s33, s32, 0x800
    buffer_load_dwordx4 v[48:51], v3, s[12:15], s33 offen
    s_add_u32 s33, s32, 0x100800
    buffer_load_dwordx4 v[52:55], v3, s[12:15], s33 offen
    s_add_u32 s33, s32, 0x200800
    buffer_load_dwordx4 v[56:59], v3, s[12:15], s33 offen
    s_add_u32 s33, s32, 0x300800
    buffer_load_dwordx4 v[60:63], v3, s[12:15], s33 offen
    s_add_u32 s33, s32, 0x1000
    buffer_load_dwordx4 v[64:67], v3, s[12:15], s33 offen
    s_add_u32 s33, s32, 0x101000
    buffer_load_dwordx4 v[68:71], v3, s[12:15], s33 offen
    s_add_u32 s33, s32, 0x201000
    buffer_load_dwordx4 v[72:75], v3, s[12:15], s33 offen
    s_add_u32 s33, s32, 0x301000
    buffer_load_dwordx4 v[76:79], v3, s[12:15], s33 offen
    s_add_u32 s33, s32, 0x1800
    buffer_load_dwordx4 v[80:83], v3, s[12:15], s33 offen
    s_add_u32 s33, s32, 0x101800
    buffer_load_dwordx4 v[84:87], v3, s[12:15], s33 offen
    s_add_u32 s33, s32, 0x201800
    buffer_load_dwordx4 v[88:91], v3, s[12:15], s33 offen
    s_add_u32 s33, s32, 0x301800
    buffer_load_dwordx4 v[92:95], v3, s[12:15], s33 offen
    buffer_load_dwordx4 v[96:99], v5, s[16:19], 0 offen offset:0
    buffer_load_dwordx4 v[104:107], v5, s[36:39], 0 offen offset:0
    buffer_load_dwordx4 v[100:103], v5, s[16:19], 0 offen offset:64
    buffer_load_dwordx4 v[108:111], v5, s[36:39], 0 offen offset:64
    buffer_load_dwordx4 v[112:115], v9, s[16:19], 0 offen offset:0
    buffer_load_dwordx4 v[120:123], v9, s[36:39], 0 offen offset:0
    buffer_load_dwordx4 v[116:119], v9, s[16:19], 0 offen offset:32
    buffer_load_dwordx4 v[124:127], v9, s[36:39], 0 offen offset:32
    v_lshrrev_b32 v10, 2, v2
    v_lshlrev_b32 v10, 6, v10
    v_and_b32 v11, 3, v2
    v_lshlrev_b32 v12, 1, v7
    v_xor_b32 v11, v11, v12
    v_lshlrev_b32 v11, 4, v11
    v_add_u32 v10, v10, v11
    s_lshl_b32 s33, s24, 12
    s_add_u32 s33, s33, 32768
    v_add_u32 v10, s33, v10
    v_lshrrev_b32 v13, 4, v2
    v_bfe_u32 v14, v2, 2, 2
    v_lshlrev_b32 v11, 3, v13
    v_add_u32 v11, v11, v14
    v_lshlrev_b32 v11, 6, v11
    v_and_b32 v15, 1, v13
    v_lshlrev_b32 v15, 5, v15
    v_add_u32 v11, v11, v15
    v_and_b32 v15, 3, v2
    v_lshlrev_b32 v15, 3, v15
    v_add_u32 v11, v11, v15
    v_add_u32 v11, s33, v11
    v_xor_b32 v12, 32, v11
    v_and_b32 v16, 7, v2
    v_bfe_u32 v17, v2, 3, 1
    v_lshlrev_b32 v18, 12, v16
    v_lshlrev_b32 v17, 11, v17
    v_add_u32 v18, v18, v17
    v_and_b32 v17, 3, v16
    v_lshlrev_b32 v17, 6, v17
    v_add_u32 v18, v18, v17
    v_bfe_u32 v17, v16, 2, 1
    v_lshlrev_b32 v17, 5, v17
    v_add_u32 v18, v18, v17
    v_lshlrev_b32 v17, 3, v13
    v_add_u32 v18, v18, v17
    s_lshl_b32 s34, s24, 8
    v_add_u32 v18, s34, v18
    v_and_b32 v17, 8, v2
    v_cmp_ne_u32 vcc, 0, v17
    s_waitcnt vmcnt(4)
    s_nop 0
    v_cndmask_b32 v96, v96, v104, vcc
    v_cndmask_b32 v97, v97, v105, vcc
    v_cndmask_b32 v98, v98, v106, vcc
    v_cndmask_b32 v99, v99, v107, vcc
    v_cndmask_b32 v100, v100, v108, vcc
    v_cndmask_b32 v101, v101, v109, vcc
    v_cndmask_b32 v102, v102, v110, vcc
    v_cndmask_b32 v103, v103, v111, vcc
    ds_write_b128 v10, v[32:35] offset:0
    ds_write_b128 v10, v[36:39] offset:1024
    ds_write_b128 v10, v[40:43] offset:2048
    ds_write_b128 v10, v[44:47] offset:3072
    s_waitcnt lgkmcnt(0)
    ds_read_b64_tr_b16 v[32:33], v11 offset:0
    ds_read_b64_tr_b16 v[34:35], v11 offset:256
    ds_read_b64_tr_b16 v[36:37], v11 offset:2048
    ds_read_b64_tr_b16 v[38:39], v11 offset:2304
    ds_read_b64_tr_b16 v[40:41], v12 offset:0
    ds_read_b64_tr_b16 v[42:43], v12 offset:256
    ds_read_b64_tr_b16 v[44:45], v12 offset:2048
    ds_read_b64_tr_b16 v[46:47], v12 offset:2304
    s_waitcnt lgkmcnt(4)
    v_mfma_f32_16x16x32_bf16 v[28:31], v[32:35], v[96:99], 0
    v_mfma_f32_16x16x32_bf16 v[28:31], v[36:39], v[100:103], v[28:31]
    s_waitcnt lgkmcnt(0)
    v_mfma_f32_16x16x32_bf16 v[104:107], v[40:43], v[96:99], 0
    v_mfma_f32_16x16x32_bf16 v[104:107], v[44:47], v[100:103], v[104:107]
    v_xor_b32 v19, 0, v18
    v_xor_b32 v20, 32, v19
    s_nop 5
    v_cvt_pk_bf16_f32 v22, v28, v29
    v_cvt_pk_bf16_f32 v23, v30, v31
    v_cvt_pk_bf16_f32 v24, v104, v105
    v_cvt_pk_bf16_f32 v25, v106, v107
    ds_write_b64 v19, v[22:23]
    ds_write_b64 v20, v[24:25]
    ds_write_b128 v10, v[48:51] offset:0
    ds_write_b128 v10, v[52:55] offset:1024
    ds_write_b128 v10, v[56:59] offset:2048
    ds_write_b128 v10, v[60:63] offset:3072
    s_waitcnt lgkmcnt(0)
    ds_read_b64_tr_b16 v[48:49], v11 offset:0
    ds_read_b64_tr_b16 v[50:51], v11 offset:256
    ds_read_b64_tr_b16 v[52:53], v11 offset:2048
    ds_read_b64_tr_b16 v[54:55], v11 offset:2304
    ds_read_b64_tr_b16 v[56:57], v12 offset:0
    ds_read_b64_tr_b16 v[58:59], v12 offset:256
    ds_read_b64_tr_b16 v[60:61], v12 offset:2048
    ds_read_b64_tr_b16 v[62:63], v12 offset:2304
    s_waitcnt lgkmcnt(4)
    v_mfma_f32_16x16x32_bf16 v[28:31], v[48:51], v[96:99], 0
    v_mfma_f32_16x16x32_bf16 v[28:31], v[52:55], v[100:103], v[28:31]
    s_waitcnt lgkmcnt(0)
    v_mfma_f32_16x16x32_bf16 v[104:107], v[56:59], v[96:99], 0
    v_mfma_f32_16x16x32_bf16 v[104:107], v[60:63], v[100:103], v[104:107]
    v_xor_b32 v19, 64, v18
    v_xor_b32 v20, 32, v19
    s_nop 5
    v_cvt_pk_bf16_f32 v22, v28, v29
    v_cvt_pk_bf16_f32 v23, v30, v31
    v_cvt_pk_bf16_f32 v24, v104, v105
    v_cvt_pk_bf16_f32 v25, v106, v107
    ds_write_b64 v19, v[22:23]
    ds_write_b64 v20, v[24:25]
    ds_write_b128 v10, v[64:67] offset:0
    ds_write_b128 v10, v[68:71] offset:1024
    ds_write_b128 v10, v[72:75] offset:2048
    ds_write_b128 v10, v[76:79] offset:3072
    s_waitcnt lgkmcnt(0)
    ds_read_b64_tr_b16 v[64:65], v11 offset:0
    ds_read_b64_tr_b16 v[66:67], v11 offset:256
    ds_read_b64_tr_b16 v[68:69], v11 offset:2048
    ds_read_b64_tr_b16 v[70:71], v11 offset:2304
    ds_read_b64_tr_b16 v[72:73], v12 offset:0
    ds_read_b64_tr_b16 v[74:75], v12 offset:256
    ds_read_b64_tr_b16 v[76:77], v12 offset:2048
    ds_read_b64_tr_b16 v[78:79], v12 offset:2304
    s_waitcnt lgkmcnt(4)
    v_mfma_f32_16x16x32_bf16 v[28:31], v[64:67], v[96:99], 0
    v_mfma_f32_16x16x32_bf16 v[28:31], v[68:71], v[100:103], v[28:31]
    s_waitcnt lgkmcnt(0)
    v_mfma_f32_16x16x32_bf16 v[104:107], v[72:75], v[96:99], 0
    v_mfma_f32_16x16x32_bf16 v[104:107], v[76:79], v[100:103], v[104:107]
    v_xor_b32 v19, 128, v18
    v_xor_b32 v20, 32, v19
    s_nop 5
    v_cvt_pk_bf16_f32 v22, v28, v29
    v_cvt_pk_bf16_f32 v23, v30, v31
    v_cvt_pk_bf16_f32 v24, v104, v105
    v_cvt_pk_bf16_f32 v25, v106, v107
    ds_write_b64 v19, v[22:23]
    ds_write_b64 v20, v[24:25]
    ds_write_b128 v10, v[80:83] offset:0
    ds_write_b128 v10, v[84:87] offset:1024
    ds_write_b128 v10, v[88:91] offset:2048
    ds_write_b128 v10, v[92:95] offset:3072
    s_waitcnt lgkmcnt(0)
    ds_read_b64_tr_b16 v[80:81], v11 offset:0
    ds_read_b64_tr_b16 v[82:83], v11 offset:256
    ds_read_b64_tr_b16 v[84:85], v11 offset:2048
    ds_read_b64_tr_b16 v[86:87], v11 offset:2304
    ds_read_b64_tr_b16 v[88:89], v12 offset:0
    ds_read_b64_tr_b16 v[90:91], v12 offset:256
    ds_read_b64_tr_b16 v[92:93], v12 offset:2048
    ds_read_b64_tr_b16 v[94:95], v12 offset:2304
    s_waitcnt lgkmcnt(4)
    v_mfma_f32_16x16x32_bf16 v[28:31], v[80:83], v[96:99], 0
    v_mfma_f32_16x16x32_bf16 v[28:31], v[84:87], v[100:103], v[28:31]
    s_waitcnt lgkmcnt(0)
    v_mfma_f32_16x16x32_bf16 v[104:107], v[88:91], v[96:99], 0
    v_mfma_f32_16x16x32_bf16 v[104:107], v[92:95], v[100:103], v[104:107]
    v_xor_b32 v19, 192, v18
    v_xor_b32 v20, 32, v19
    s_nop 5
    v_cvt_pk_bf16_f32 v22, v28, v29
    v_cvt_pk_bf16_f32 v23, v30, v31
    v_cvt_pk_bf16_f32 v24, v104, v105
    v_cvt_pk_bf16_f32 v25, v106, v107
    ds_write_b64 v19, v[22:23]
    ds_write_b64 v20, v[24:25]
    v_and_b32 v17, 16, v2
    v_cmp_ne_u32 vcc, 0, v17
    s_mov_b32 s40, 0x80008000
    s_cmp_eq_u32 s31, 0
    s_cselect_b32 s42, 0x10000, 0
    s_mov_b32 s43, s42
    v_mov_b32 v17, 0xbf803f80
    s_waitcnt vmcnt(0)
    v_xor_b32 v48, s40, v120
    v_cndmask_b32 v32, v112, v120, vcc
    v_xor_b32 v49, s40, v121
    v_cndmask_b32 v33, v113, v121, vcc
    v_xor_b32 v50, s40, v122
    v_cndmask_b32 v34, v114, v122, vcc
    v_xor_b32 v51, s40, v123
    v_cndmask_b32 v35, v115, v123, vcc
    v_xor_b32 v52, s40, v124
    v_cndmask_b32 v36, v116, v124, vcc
    v_xor_b32 v53, s40, v125
    v_cndmask_b32 v37, v117, v125, vcc
    v_xor_b32 v54, s40, v126
    v_cndmask_b32 v38, v118, v126, vcc
    v_xor_b32 v55, s40, v127
    v_cndmask_b32 v39, v119, v127, vcc
    v_cndmask_b32 v40, v48, v112, vcc
    v_cndmask_b32 v32, v32, v17, s[42:43]
    v_cndmask_b32 v41, v49, v113, vcc
    v_cndmask_b32 v33, v33, v17, s[42:43]
    v_cndmask_b32 v42, v50, v114, vcc
    v_cndmask_b32 v34, v34, v17, s[42:43]
    v_cndmask_b32 v43, v51, v115, vcc
    v_cndmask_b32 v35, v35, v17, s[42:43]
    v_cndmask_b32 v44, v52, v116, vcc
    v_cndmask_b32 v36, v36, v17, s[42:43]
    v_cndmask_b32 v45, v53, v117, vcc
    v_cndmask_b32 v37, v37, v17, s[42:43]
    v_cndmask_b32 v46, v54, v118, vcc
    v_cndmask_b32 v38, v38, v17, s[42:43]
    v_cndmask_b32 v47, v55, v119, vcc
    v_cndmask_b32 v39, v39, v17, s[42:43]
    s_and_b32 s33, s24, 3
    v_xor_b32 v11, s33, v14
    v_lshlrev_b32 v12, 3, v7
    v_add_u32 v11, v11, v12
    v_lshlrev_b32 v11, 6, v11
    s_bfe_u32 s33, s24, 0x10002
    v_bfe_u32 v12, v2, 4, 1
    v_xor_b32 v12, s33, v12
    v_lshlrev_b32 v12, 5, v12
    v_add_u32 v11, v11, v12
    v_add_u32 v11, v11, v15
    s_lshl_b32 s33, s24, 12
    v_add_u32 v11, s33, v11
    s_waitcnt lgkmcnt(0)
    s_barrier
    ds_read_b64_tr_b16 v[64:65], v11 offset:0
    ds_read_b64_tr_b16 v[66:67], v11 offset:256
    ds_read_b64_tr_b16 v[68:69], v11 offset:1024
    ds_read_b64_tr_b16 v[70:71], v11 offset:1280
    ds_read_b64_tr_b16 v[72:73], v11 offset:2048
    ds_read_b64_tr_b16 v[74:75], v11 offset:2304
    ds_read_b64_tr_b16 v[76:77], v11 offset:3072
    ds_read_b64_tr_b16 v[78:79], v11 offset:3328
    v_and_b32 v12, 15, v2
    v_lshlrev_b32 v12, 18, v12
    v_bfe_u32 v13, v2, 4, 1
    v_lshlrev_b32 v13, 11, v13
    v_add_u32 v12, v12, v13
    v_add_u32 v12, v12, v8
    s_lshl_b32 s33, s31, 12
    s_lshl_b32 s34, s27, 6
    s_add_u32 s33, s33, s34
    s_add_u32 s33, s33, 0x1000000
    s_waitcnt lgkmcnt(6)
    v_mfma_f32_32x32x16_bf16 v[80:95], v[64:67], v[32:35], 0
    s_waitcnt lgkmcnt(4)
    v_mfma_f32_32x32x16_bf16 v[80:95], v[68:71], v[36:39], v[80:95]
    s_waitcnt lgkmcnt(2)
    v_mfma_f32_32x32x16_bf16 v[80:95], v[72:75], v[40:43], v[80:95]
    s_waitcnt lgkmcnt(0)
    v_mfma_f32_32x32x16_bf16 v[80:95], v[76:79], v[44:47], v[80:95]
    s_nop 15
    s_nop 3
    v_cvt_pk_bf16_f32 v80, v80, v81
    v_cvt_pk_bf16_f32 v81, v82, v83
    v_cvt_pk_bf16_f32 v82, v84, v85
    v_cvt_pk_bf16_f32 v83, v86, v87
    v_cvt_pk_bf16_f32 v84, v88, v89
    v_cvt_pk_bf16_f32 v85, v90, v91
    v_cvt_pk_bf16_f32 v86, v92, v93
    v_cvt_pk_bf16_f32 v87, v94, v95
    s_nop 1
    v_permlane32_swap_b32 v80, v82
    v_permlane32_swap_b32 v81, v83
    v_permlane32_swap_b32 v84, v86
    v_permlane32_swap_b32 v85, v87
    s_nop 1
    buffer_store_dwordx4 v[80:83], v12, s[20:23], s33 offen sc1
    buffer_store_dwordx4 v[84:87], v12, s[20:23], s33 offen offset:32 sc1
    s_load_dwordx2 s[4:5], s[0:1], 16
    s_load_dwordx2 s[6:7], s[0:1], 64
    s_waitcnt vmcnt(0)
    s_barrier
    s_cmp_lg_u32 s24, 0
    s_cbranch_scc1 KF_NOFLAG
    s_lshl_b32 s33, s26, 5
    s_add_u32 s33, s33, s27
    s_lshl_b32 s33, s33, 2
    s_add_u32 s33, s33, 0x2002000
    v_mov_b32 v6, 1
    v_mov_b32 v7, 0
    s_mov_b64 exec, 1
    buffer_store_dword v6, v7, s[20:23], s33 offen sc1
    s_mov_b64 exec, -1
KF_NOFLAG:
    v_lshlrev_b32 v3, 4, v2
    s_cmp_ge_u32 s24, 4
    s_cbranch_scc1 KF_WO
    s_lshl_b32 s35, s25, 2
    s_add_u32 s35, s35, s24
    s_lshl_b32 s44, s24, 12
    s_add_u32 s44, s44, 0x10000
    s_mov_b32 s45, 0x2004000
    buffer_load_dwordx4 v[16:19], v3, s[20:23], s45 offen offset:0
    buffer_load_dwordx4 v[20:23], v3, s[20:23], s45 offen offset:1024
    buffer_load_dwordx4 v[24:27], v3, s[20:23], s45 offen offset:2048
    buffer_load_dwordx4 v[28:31], v3, s[20:23], s45 offen offset:3072
    s_add_u32 s45, s45, 4096
    buffer_load_dwordx4 v[96:99], v3, s[20:23], s45 offen offset:0
    buffer_load_dwordx4 v[100:103], v3, s[20:23], s45 offen offset:1024
    buffer_load_dwordx4 v[104:107], v3, s[20:23], s45 offen offset:2048
    buffer_load_dwordx4 v[108:111], v3, s[20:23], s45 offen offset:3072
    s_add_u32 s45, s45, 4096
    buffer_load_dwordx4 v[112:115], v3, s[20:23], s45 offen offset:0
    buffer_load_dwordx4 v[116:119], v3, s[20:23], s45 offen offset:1024
    buffer_load_dwordx4 v[120:123], v3, s[20:23], s45 offen offset:2048
    buffer_load_dwordx4 v[124:127], v3, s[20:23], s45 offen offset:3072
    v_lshrrev_b32 v11, 5, v2
    v_bfe_u32 v12, v2, 2, 2
    v_lshlrev_b32 v13, 2, v11
    v_add_u32 v13, v13, v12
    v_lshlrev_b32 v13, 6, v13
    v_bfe_u32 v12, v2, 4, 1
    v_lshlrev_b32 v12, 5, v12
    v_add_u32 v13, v13, v12
    v_and_b32 v12, 3, v2
    v_lshlrev_b32 v12, 3, v12
    v_add_u32 v13, v13, v12
    v_add_u32 v13, s44, v13
    v_and_b32 v14, 15, v2
    v_lshlrev_b32 v14, 6, v14
    v_lshlrev_b32 v12, 4, v11
    v_add_u32 v14, v14, v12
    v_bfe_u32 v12, v2, 4, 1
    v_lshlrev_b32 v12, 5, v12
    v_add_u32 v14, v14, v12
    v_add_u32 v15, s44, v3
    s_waitcnt lgkmcnt(0)
    s_mov_b32 s16, s6
    s_mov_b32 s17, s7
    s_mov_b32 s18, 0x800000
    s_mov_b32 s19, 0x20000
    s_cmp_lg_u32 s24, 0
    s_cbranch_scc1 KF_ZOK
    s_bfe_u32 s45, s25, 0x30001
    s_lshl_b32 s45, s45, 7
    s_add_u32 s45, s45, 0x2002000
    v_and_b32 v4, 31, v2
    v_lshlrev_b32 v4, 2, v4
KF_ZPOLL:
    buffer_load_dword v5, v4, s[20:23], s45 offen sc1
    s_waitcnt vmcnt(0)
    v_cmp_ne_u32 vcc, 1, v5
    s_cmp_eq_u64 vcc, 0
    s_cbranch_scc1 KF_ZOK
    s_sleep 8
    s_branch KF_ZPOLL
KF_ZOK:
    s_barrier
KF_P2T:
    s_lshl_b32 s45, s35, 12
    s_cmp_eq_u32 s35, 1024
    s_cselect_b32 s45, 2048, s45
    s_add_u32 s45, s45, 0x1000000
    s_lshl_b32 s46, s35, 12
    s_add_u32 s46, s46, 0x1000800
    s_cmp_eq_u32 s35, 1024
    s_cselect_b32 s46, s45, s46
    buffer_load_dwordx4 v[32:35], v3, s[20:23], s45 offen sc1
    buffer_load_dwordx4 v[36:39], v3, s[20:23], s45 offen offset:1024 sc1
    buffer_load_dwordx4 v[40:43], v3, s[20:23], s46 offen sc1
    buffer_load_dwordx4 v[44:47], v3, s[20:23], s46 offen offset:1024 sc1
    s_waitcnt vmcnt(3)
    ds_write_b128 v15, v[32:35] offset:0
    s_waitcnt vmcnt(2)
    ds_write_b128 v15, v[36:39] offset:1024
    s_waitcnt vmcnt(1)
    ds_write_b128 v15, v[40:43] offset:2048
    s_waitcnt vmcnt(0)
    ds_write_b128 v15, v[44:47] offset:3072
    s_waitcnt lgkmcnt(0)
    ds_read_b64_tr_b16 v[80:81], v13 offset:0
    ds_read_b64_tr_b16 v[82:83], v13 offset:512
    ds_read_b64_tr_b16 v[84:85], v13 offset:1024
    ds_read_b64_tr_b16 v[86:87], v13 offset:1536
    ds_read_b64_tr_b16 v[4:5], v13 offset:2048
    ds_read_b64_tr_b16 v[6:7], v13 offset:2560
    ds_read_b64_tr_b16 v[8:9], v13 offset:3072
    ds_read_b64_tr_b16 v[10:11], v13 offset:3584
    s_and_b32 s45, s35, 1023
    s_cmp_eq_u32 s45, 0
    s_cselect_b32 s45, 0, -1
    s_waitcnt lgkmcnt(0)
    v_and_b32 v4, s45, v4
    v_and_b32 v5, s45, v5
    v_and_b32 v6, s45, v6
    v_and_b32 v7, s45, v7
    v_and_b32 v8, s45, v8
    v_and_b32 v9, s45, v9
    v_and_b32 v10, s45, v10
    v_and_b32 v11, s45, v11
    s_nop 1
    v_mfma_f32_32x32x16_bf16 v[32:47], v[80:83], v[16:19], 0
    v_mfma_f32_32x32x16_bf16 v[32:47], v[84:87], v[20:23], v[32:47]
    v_mfma_f32_32x32x16_bf16 v[48:63], v[80:83], v[24:27], 0
    v_mfma_f32_32x32x16_bf16 v[48:63], v[84:87], v[28:31], v[48:63]
    v_mfma_f32_32x32x16_bf16 v[64:79], v[4:7], v[16:19], 0
    v_mfma_f32_32x32x16_bf16 v[64:79], v[8:11], v[20:23], v[64:79]
    v_mfma_f32_32x32x16_bf16 v[80:95], v[4:7], v[24:27], 0
    v_mfma_f32_32x32x16_bf16 v[80:95], v[8:11], v[28:31], v[80:95]
    s_nop 15
    s_nop 3
    v_pk_mul_f32 v[4:5], v[48:49], v[112:113]
    v_pk_mul_f32 v[6:7], v[48:49], v[96:97]
    v_pk_mul_f32 v[8:9], v[80:81], v[112:113]
    v_pk_mul_f32 v[10:11], v[80:81], v[96:97]
    v_pk_fma_f32 v[48:49], v[32:33], v[112:113], v[6:7] neg_lo:[1,0,1] neg_hi:[1,0,1]
    v_pk_fma_f32 v[32:33], v[32:33], v[96:97], v[4:5] neg_lo:[0,0,1] neg_hi:[0,0,1]
    v_pk_fma_f32 v[80:81], v[64:65], v[112:113], v[10:11]
    v_pk_fma_f32 v[64:65], v[64:65], v[96:97], v[8:9] neg_lo:[0,0,1] neg_hi:[0,0,1]
    v_pk_mul_f32 v[4:5], v[50:51], v[114:115]
    v_pk_mul_f32 v[6:7], v[50:51], v[98:99]
    v_pk_mul_f32 v[8:9], v[82:83], v[114:115]
    v_pk_mul_f32 v[10:11], v[82:83], v[98:99]
    v_pk_fma_f32 v[50:51], v[34:35], v[114:115], v[6:7] neg_lo:[1,0,1] neg_hi:[1,0,1]
    v_pk_fma_f32 v[34:35], v[34:35], v[98:99], v[4:5] neg_lo:[0,0,1] neg_hi:[0,0,1]
    v_pk_fma_f32 v[82:83], v[66:67], v[114:115], v[10:11]
    v_pk_fma_f32 v[66:67], v[66:67], v[98:99], v[8:9] neg_lo:[0,0,1] neg_hi:[0,0,1]
    v_pk_mul_f32 v[4:5], v[52:53], v[116:117]
    v_pk_mul_f32 v[6:7], v[52:53], v[100:101]
    v_pk_mul_f32 v[8:9], v[84:85], v[116:117]
    v_pk_mul_f32 v[10:11], v[84:85], v[100:101]
    v_pk_fma_f32 v[52:53], v[36:37], v[116:117], v[6:7] neg_lo:[1,0,1] neg_hi:[1,0,1]
    v_pk_fma_f32 v[36:37], v[36:37], v[100:101], v[4:5] neg_lo:[0,0,1] neg_hi:[0,0,1]
    v_pk_fma_f32 v[84:85], v[68:69], v[116:117], v[10:11]
    v_pk_fma_f32 v[68:69], v[68:69], v[100:101], v[8:9] neg_lo:[0,0,1] neg_hi:[0,0,1]
    v_pk_mul_f32 v[4:5], v[54:55], v[118:119]
    v_pk_mul_f32 v[6:7], v[54:55], v[102:103]
    v_pk_mul_f32 v[8:9], v[86:87], v[118:119]
    v_pk_mul_f32 v[10:11], v[86:87], v[102:103]
    v_pk_fma_f32 v[54:55], v[38:39], v[118:119], v[6:7] neg_lo:[1,0,1] neg_hi:[1,0,1]
    v_pk_fma_f32 v[38:39], v[38:39], v[102:103], v[4:5] neg_lo:[0,0,1] neg_hi:[0,0,1]
    v_pk_fma_f32 v[86:87], v[70:71], v[118:119], v[10:11]
    v_pk_fma_f32 v[70:71], v[70:71], v[102:103], v[8:9] neg_lo:[0,0,1] neg_hi:[0,0,1]
    v_pk_mul_f32 v[4:5], v[56:57], v[120:121]
    v_pk_mul_f32 v[6:7], v[56:57], v[104:105]
    v_pk_mul_f32 v[8:9], v[88:89], v[120:121]
    v_pk_mul_f32 v[10:11], v[88:89], v[104:105]
    v_pk_fma_f32 v[56:57], v[40:41], v[120:121], v[6:7] neg_lo:[1,0,1] neg_hi:[1,0,1]
    v_pk_fma_f32 v[40:41], v[40:41], v[104:105], v[4:5] neg_lo:[0,0,1] neg_hi:[0,0,1]
    v_pk_fma_f32 v[88:89], v[72:73], v[120:121], v[10:11]
    v_pk_fma_f32 v[72:73], v[72:73], v[104:105], v[8:9] neg_lo:[0,0,1] neg_hi:[0,0,1]
    v_pk_mul_f32 v[4:5], v[58:59], v[122:123]
    v_pk_mul_f32 v[6:7], v[58:59], v[106:107]
    v_pk_mul_f32 v[8:9], v[90:91], v[122:123]
    v_pk_mul_f32 v[10:11], v[90:91], v[106:107]
    v_pk_fma_f32 v[58:59], v[42:43], v[122:123], v[6:7] neg_lo:[1,0,1] neg_hi:[1,0,1]
    v_pk_fma_f32 v[42:43], v[42:43], v[106:107], v[4:5] neg_lo:[0,0,1] neg_hi:[0,0,1]
    v_pk_fma_f32 v[90:91], v[74:75], v[122:123], v[10:11]
    v_pk_fma_f32 v[74:75], v[74:75], v[106:107], v[8:9] neg_lo:[0,0,1] neg_hi:[0,0,1]
    v_pk_mul_f32 v[4:5], v[60:61], v[124:125]
    v_pk_mul_f32 v[6:7], v[60:61], v[108:109]
    v_pk_mul_f32 v[8:9], v[92:93], v[124:125]
    v_pk_mul_f32 v[10:11], v[92:93], v[108:109]
    v_pk_fma_f32 v[60:61], v[44:45], v[124:125], v[6:7] neg_lo:[1,0,1] neg_hi:[1,0,1]
    v_pk_fma_f32 v[44:45], v[44:45], v[108:109], v[4:5] neg_lo:[0,0,1] neg_hi:[0,0,1]
    v_pk_fma_f32 v[92:93], v[76:77], v[124:125], v[10:11]
    v_pk_fma_f32 v[76:77], v[76:77], v[108:109], v[8:9] neg_lo:[0,0,1] neg_hi:[0,0,1]
    v_pk_mul_f32 v[4:5], v[62:63], v[126:127]
    v_pk_mul_f32 v[6:7], v[62:63], v[110:111]
    v_pk_mul_f32 v[8:9], v[94:95], v[126:127]
    v_pk_mul_f32 v[10:11], v[94:95], v[110:111]
    v_pk_fma_f32 v[62:63], v[46:47], v[126:127], v[6:7] neg_lo:[1,0,1] neg_hi:[1,0,1]
    v_pk_fma_f32 v[46:47], v[46:47], v[110:111], v[4:5] neg_lo:[0,0,1] neg_hi:[0,0,1]
    v_pk_fma_f32 v[94:95], v[78:79], v[126:127], v[10:11]
    v_pk_fma_f32 v[78:79], v[78:79], v[110:111], v[8:9] neg_lo:[0,0,1] neg_hi:[0,0,1]
    v_cvt_pk_bf16_f32 v32, v32, v33
    v_cvt_pk_bf16_f32 v33, v34, v35
    v_cvt_pk_bf16_f32 v34, v36, v37
    v_cvt_pk_bf16_f32 v35, v38, v39
    v_cvt_pk_bf16_f32 v36, v40, v41
    v_cvt_pk_bf16_f32 v37, v42, v43
    v_cvt_pk_bf16_f32 v38, v44, v45
    v_cvt_pk_bf16_f32 v39, v46, v47
    v_cvt_pk_bf16_f32 v40, v48, v49
    v_cvt_pk_bf16_f32 v41, v50, v51
    v_cvt_pk_bf16_f32 v42, v52, v53
    v_cvt_pk_bf16_f32 v43, v54, v55
    v_cvt_pk_bf16_f32 v44, v56, v57
    v_cvt_pk_bf16_f32 v45, v58, v59
    v_cvt_pk_bf16_f32 v46, v60, v61
    v_cvt_pk_bf16_f32 v47, v62, v63
    v_cvt_pk_bf16_f32 v48, v80, v81
    v_cvt_pk_bf16_f32 v49, v82, v83
    v_cvt_pk_bf16_f32 v50, v84, v85
    v_cvt_pk_bf16_f32 v51, v86, v87
    v_cvt_pk_bf16_f32 v52, v88, v89
    v_cvt_pk_bf16_f32 v53, v90, v91
    v_cvt_pk_bf16_f32 v54, v92, v93
    v_cvt_pk_bf16_f32 v55, v94, v95
    v_cvt_pk_bf16_f32 v56, v64, v65
    v_cvt_pk_bf16_f32 v57, v66, v67
    v_cvt_pk_bf16_f32 v58, v68, v69
    v_cvt_pk_bf16_f32 v59, v70, v71
    v_cvt_pk_bf16_f32 v60, v72, v73
    v_cvt_pk_bf16_f32 v61, v74, v75
    v_cvt_pk_bf16_f32 v62, v76, v77
    v_cvt_pk_bf16_f32 v63, v78, v79
    s_nop 1
    v_mfma_f32_32x32x16_bf16 v[64:79], v[32:35], v[16:19], 0
    v_mfma_f32_32x32x16_bf16 v[80:95], v[48:51], v[16:19], 0
    v_mfma_f32_32x32x16_bf16 v[64:79], v[36:39], v[20:23], v[64:79]
    v_mfma_f32_32x32x16_bf16 v[80:95], v[52:55], v[20:23], v[80:95]
    v_mfma_f32_32x32x16_bf16 v[64:79], v[40:43], v[24:27], v[64:79]
    v_mfma_f32_32x32x16_bf16 v[80:95], v[56:59], v[24:27], v[80:95]
    v_mfma_f32_32x32x16_bf16 v[64:79], v[44:47], v[28:31], v[64:79]
    v_mfma_f32_32x32x16_bf16 v[80:95], v[60:63], v[28:31], v[80:95]
    s_lshl_b32 s45, s35, 12
    s_add_u32 s45, s45, 2048
    s_sub_u32 s46, 2048, s35
    s_and_b32 s46, s46, 2047
    s_lshl_b32 s46, s46, 12
    s_add_u32 s46, s46, 2048
    s_nop 15
    s_nop 3
    v_pk_add_f32 v[32:33], v[64:65], v[80:81] neg_lo:[0,1] neg_hi:[0,1]
    v_pk_add_f32 v[48:49], v[64:65], v[80:81]
    v_pk_add_f32 v[34:35], v[66:67], v[82:83] neg_lo:[0,1] neg_hi:[0,1]
    v_pk_add_f32 v[50:51], v[66:67], v[82:83]
    v_pk_add_f32 v[36:37], v[68:69], v[84:85] neg_lo:[0,1] neg_hi:[0,1]
    v_pk_add_f32 v[52:53], v[68:69], v[84:85]
    v_pk_add_f32 v[38:39], v[70:71], v[86:87] neg_lo:[0,1] neg_hi:[0,1]
    v_pk_add_f32 v[54:55], v[70:71], v[86:87]
    v_pk_add_f32 v[40:41], v[72:73], v[88:89] neg_lo:[0,1] neg_hi:[0,1]
    v_pk_add_f32 v[56:57], v[72:73], v[88:89]
    v_pk_add_f32 v[42:43], v[74:75], v[90:91] neg_lo:[0,1] neg_hi:[0,1]
    v_pk_add_f32 v[58:59], v[74:75], v[90:91]
    v_pk_add_f32 v[44:45], v[76:77], v[92:93] neg_lo:[0,1] neg_hi:[0,1]
    v_pk_add_f32 v[60:61], v[76:77], v[92:93]
    v_pk_add_f32 v[46:47], v[78:79], v[94:95] neg_lo:[0,1] neg_hi:[0,1]
    v_pk_add_f32 v[62:63], v[78:79], v[94:95]
    v_cvt_pk_bf16_f32 v32, v32, v33
    v_cvt_pk_bf16_f32 v33, v34, v35
    v_cvt_pk_bf16_f32 v34, v36, v37
    v_cvt_pk_bf16_f32 v35, v38, v39
    v_cvt_pk_bf16_f32 v36, v40, v41
    v_cvt_pk_bf16_f32 v37, v42, v43
    v_cvt_pk_bf16_f32 v38, v44, v45
    v_cvt_pk_bf16_f32 v39, v46, v47
    s_nop 1
    v_permlane32_swap_b32 v32, v34
    v_permlane32_swap_b32 v33, v35
    v_permlane32_swap_b32 v36, v38
    v_permlane32_swap_b32 v37, v39
    s_nop 1
    v_permlane16_swap_b32 v32, v36
    v_permlane16_swap_b32 v33, v37
    v_permlane16_swap_b32 v34, v38
    v_permlane16_swap_b32 v35, v39
    s_nop 1
    buffer_store_dwordx4 v[32:35], v14, s[16:19], s45 offen sc1
    buffer_store_dwordx4 v[36:39], v14, s[16:19], s45 offen offset:1024 sc1
    v_cvt_pk_bf16_f32 v48, v48, v49
    v_cvt_pk_bf16_f32 v49, v50, v51
    v_cvt_pk_bf16_f32 v50, v52, v53
    v_cvt_pk_bf16_f32 v51, v54, v55
    v_cvt_pk_bf16_f32 v52, v56, v57
    v_cvt_pk_bf16_f32 v53, v58, v59
    v_cvt_pk_bf16_f32 v54, v60, v61
    v_cvt_pk_bf16_f32 v55, v62, v63
    s_nop 1
    v_permlane32_swap_b32 v48, v50
    v_permlane32_swap_b32 v49, v51
    v_permlane32_swap_b32 v52, v54
    v_permlane32_swap_b32 v53, v55
    s_nop 1
    v_permlane16_swap_b32 v48, v52
    v_permlane16_swap_b32 v49, v53
    v_permlane16_swap_b32 v50, v54
    v_permlane16_swap_b32 v51, v55
    s_nop 1
    buffer_store_dwordx4 v[48:51], v14, s[16:19], s46 offen sc1
    buffer_store_dwordx4 v[52:55], v14, s[16:19], s46 offen offset:1024 sc1
    s_cmp_lg_u32 s35, 0
    s_cbranch_scc1 KF_P2E
    s_mov_b32 s35, 1024
    s_branch KF_P2T
KF_P2E:
    s_cmp_lg_u32 s24, 0
    s_cbranch_scc1 KF_WST
    s_setprio 0
    s_and_b32 s28, s25, 7
    s_lshr_b32 s29, s25, 3
    s_lshr_b32 s30, s28, 1
    s_lshl_b32 s30, s30, 2
    s_and_b32 s31, s29, 3
    s_add_u32 s36, s30, s31
    s_and_b32 s30, s28, 1
    s_lshl_b32 s30, s30, 3
    s_lshr_b32 s58, s29, 2
    s_add_u32 s26, s30, s58
    s_mov_b32 s58, 0
    v_lshlrev_b32 v4, 3, v2
    s_lshl_b32 s45, s36, 9
    s_add_u32 s45, s45, 0x2000000
    s_mov_b32 s52, 0x00030003
    s_mov_b32 s53, 0x00030003
    s_mov_b64 s[50:51], 0
    s_mov_b32 s40, 0
    s_lshl_b32 s41, s58, 1
    s_lshl_b64 s[46:47], s[52:53], s41
KF_PL0:
    s_add_u32 s41, s40, s58
    s_add_u32 s41, s41, 1
    s_and_b32 s41, s41, 7
    s_lshl_b32 s41, s41, 1
    s_lshl_b64 s[48:49], s[52:53], s41
    s_or_b64 s[46:47], s[46:47], s[48:49]
    s_mov_b32 s42, 0
KF_PL1:
    s_and_b64 s[48:49], s[50:51], s[46:47]
    s_cmp_eq_u64 s[48:49], s[46:47]
    s_cbranch_scc1 KF_PL2
    s_cmp_eq_u64 s[50:51], 0
    s_cbranch_scc0 KF_PL3
    s_sleep 8
KF_PL3:
    s_sleep 1
KF_PL5:
    s_mov_b32 s42, 1
    buffer_load_dwordx2 v[8:9], v4, s[20:23], s45 offen sc1
    s_waitcnt vmcnt(0)
    v_and_b32 v8, v8, v9
    v_cmp_eq_u32 vcc, 1, v8
    s_mov_b64 s[50:51], vcc
    s_branch KF_PL1
KF_PL2:
    s_barrier
    s_add_u32 s40, s40, 1
    s_cmp_lt_u32 s40, 7
    s_cbranch_scc1 KF_PL0
    s_endpgm
KF_WST:
    s_and_b32 s28, s25, 7
    s_lshr_b32 s29, s25, 3
    s_lshr_b32 s30, s28, 1
    s_lshl_b32 s30, s30, 2
    s_and_b32 s31, s29, 3
    s_add_u32 s36, s30, s31
    s_and_b32 s30, s28, 1
    s_lshl_b32 s30, s30, 3
    s_lshr_b32 s58, s29, 2
    s_add_u32 s26, s30, s58
    s_mov_b32 s58, 0
    v_lshrrev_b32 v6, 3, v2
    v_lshlrev_b32 v6, 11, v6
    v_bfe_u32 v4, v2, 2, 1
    v_bfe_u32 v5, v2, 4, 1
    v_xor_b32 v4, v4, v5
    v_lshlrev_b32 v4, 6, v4
    v_add_u32 v6, v6, v4
    v_and_b32 v4, 3, v2
    v_lshlrev_b32 v4, 4, v4
    v_add_u32 v6, v6, v4
    v_add_u32 v7, 15360, v6
    v_add_u32 v8, 30720, v6
    v_add_u32 v9, 46080, v6
    s_mov_b32 s12, s4
    s_mov_b32 s13, s5
    s_mov_b32 s14, 0x200000
    s_mov_b32 s15, 0x20000
    s_add_u32 s38, s58, s24
    s_add_u32 s38, s38, 4
    s_and_b32 s38, s38, 7
    s_lshl_b32 s38, s38, 18
    s_lshl_b32 s39, s26, 7
    s_add_u32 s38, s38, s39
    s_add_u32 s60, s38, 0x0
    s_add_u32 s61, s38, 0x10000
    s_add_u32 s62, s38, 0x20000
    s_add_u32 s63, s38, 0x30000
    buffer_load_dwordx4 v[32:35], v6, s[12:15], s60 offen offset:0
    buffer_load_dwordx4 v[36:39], v7, s[12:15], s60 offen offset:1024
    buffer_load_dwordx4 v[40:43], v8, s[12:15], s60 offen offset:2048
    buffer_load_dwordx4 v[44:47], v9, s[12:15], s60 offen offset:3072
    buffer_load_dwordx4 v[48:51], v6, s[12:15], s61 offen offset:0
    buffer_load_dwordx4 v[52:55], v7, s[12:15], s61 offen offset:1024
    buffer_load_dwordx4 v[56:59], v8, s[12:15], s61 offen offset:2048
    buffer_load_dwordx4 v[60:63], v9, s[12:15], s61 offen offset:3072
    buffer_load_dwordx4 v[64:67], v6, s[12:15], s62 offen offset:0
    buffer_load_dwordx4 v[68:71], v7, s[12:15], s62 offen offset:1024
    buffer_load_dwordx4 v[72:75], v8, s[12:15], s62 offen offset:2048
    buffer_load_dwordx4 v[76:79], v9, s[12:15], s62 offen offset:3072
    buffer_load_dwordx4 v[80:83], v6, s[12:15], s63 offen offset:0
    buffer_load_dwordx4 v[84:87], v7, s[12:15], s63 offen offset:1024
    buffer_load_dwordx4 v[88:91], v8, s[12:15], s63 offen offset:2048
    buffer_load_dwordx4 v[92:95], v9, s[12:15], s63 offen offset:3072
    s_sub_u32 s38, s24, 1
    s_lshl_b32 s38, s38, 14
    v_add_u32 v15, s38, v3
    s_add_u32 s40, s24, 2
KF_WST1:
    s_barrier
    s_sub_u32 s40, s40, 1
    s_cmp_lg_u32 s40, 0
    s_cbranch_scc1 KF_WST1
    s_waitcnt vmcnt(0)
    ds_write_b128 v15, v[32:35] offset:0
    ds_write_b128 v15, v[36:39] offset:1024
    ds_write_b128 v15, v[40:43] offset:2048
    ds_write_b128 v15, v[44:47] offset:3072
    ds_write_b128 v15, v[48:51] offset:4096
    ds_write_b128 v15, v[52:55] offset:5120
    s_barrier
    ds_write_b128 v15, v[56:59] offset:6144
    ds_write_b128 v15, v[60:63] offset:7168
    ds_write_b128 v15, v[64:67] offset:8192
    ds_write_b128 v15, v[68:71] offset:9216
    ds_write_b128 v15, v[72:75] offset:10240
    s_barrier
    ds_write_b128 v15, v[76:79] offset:11264
    ds_write_b128 v15, v[80:83] offset:12288
    ds_write_b128 v15, v[84:87] offset:13312
    ds_write_b128 v15, v[88:91] offset:14336
    ds_write_b128 v15, v[92:95] offset:15360
    s_waitcnt lgkmcnt(0)
    s_endpgm
KF_WO:
    s_sub_u32 s24, s24, 4
    s_and_b32 s28, s25, 7
    s_lshr_b32 s29, s25, 3
    s_lshr_b32 s30, s28, 1
    s_lshl_b32 s30, s30, 2
    s_and_b32 s31, s29, 3
    s_add_u32 s36, s30, s31
    s_and_b32 s30, s28, 1
    s_lshl_b32 s30, s30, 3
    s_lshr_b32 s58, s29, 2
    s_add_u32 s26, s30, s58
    s_mov_b32 s58, 0
    v_lshrrev_b32 v6, 3, v2
    v_lshlrev_b32 v6, 11, v6
    v_bfe_u32 v4, v2, 2, 1
    v_bfe_u32 v5, v2, 4, 1
    v_xor_b32 v4, v4, v5
    v_lshlrev_b32 v4, 6, v4
    v_add_u32 v6, v6, v4
    v_and_b32 v4, 3, v2
    v_lshlrev_b32 v4, 4, v4
    v_add_u32 v6, v6, v4
    v_add_u32 v7, 15360, v6
    v_add_u32 v8, 30720, v6
    v_add_u32 v9, 46080, v6
    v_add_u32 v10, 4096, v3
    s_lshl_b32 s34, s36, 2
    s_add_u32 s34, s34, s24
    s_lshl_b32 s35, s34, 16
    s_add_u32 s35, s35, 0xc00000
    s_lshl_b32 s37, s24, 16
    s_lshl_b32 s38, s26, 7
    s_add_u32 s37, s37, s38
    s_lshl_b32 s57, s24, 12
    s_add_u32 s38, s58, 0
    s_and_b32 s38, s38, 7
    s_lshl_b32 s39, s38, 13
    s_add_u32 s60, s35, s39
    s_lshl_b32 s39, s38, 18
    s_add_u32 s68, s37, s39
    s_add_u32 s38, s58, 1
    s_and_b32 s38, s38, 7
    s_lshl_b32 s39, s38, 13
    s_add_u32 s61, s35, s39
    s_lshl_b32 s39, s38, 18
    s_add_u32 s69, s37, s39
    s_add_u32 s38, s58, 2
    s_and_b32 s38, s38, 7
    s_lshl_b32 s39, s38, 13
    s_add_u32 s62, s35, s39
    s_lshl_b32 s39, s38, 18
    s_add_u32 s70, s37, s39
    s_add_u32 s38, s58, 3
    s_and_b32 s38, s38, 7
    s_lshl_b32 s39, s38, 13
    s_add_u32 s63, s35, s39
    s_lshl_b32 s39, s38, 18
    s_add_u32 s71, s37, s39
    s_add_u32 s38, s58, 4
    s_and_b32 s38, s38, 7
    s_lshl_b32 s39, s38, 13
    s_add_u32 s64, s35, s39
    s_lshl_b32 s39, s38, 18
    s_add_u32 s72, s37, s39
    s_add_u32 s38, s58, 5
    s_and_b32 s38, s38, 7
    s_lshl_b32 s39, s38, 13
    s_add_u32 s65, s35, s39
    s_lshl_b32 s39, s38, 18
    s_add_u32 s73, s37, s39
    s_add_u32 s38, s58, 6
    s_and_b32 s38, s38, 7
    s_lshl_b32 s39, s38, 13
    s_add_u32 s66, s35, s39
    s_lshl_b32 s39, s38, 18
    s_add_u32 s74, s37, s39
    s_add_u32 s38, s58, 7
    s_and_b32 s38, s38, 7
    s_lshl_b32 s39, s38, 13
    s_add_u32 s67, s35, s39
    s_lshl_b32 s39, s38, 18
    s_add_u32 s75, s37, s39
    s_waitcnt lgkmcnt(0)
    s_mov_b32 s12, s4
    s_mov_b32 s13, s5
    s_mov_b32 s14, 0x200000
    s_mov_b32 s15, 0x20000
    s_mov_b32 s16, s6
    s_mov_b32 s17, s7
    s_mov_b32 s18, 0x800000
    s_mov_b32 s19, 0x20000
    s_add_u32 m0, s57, 0x0
    s_nop 0
    buffer_load_dwordx4 v6, s[12:15], s68 offen offset:0 lds
    buffer_load_dwordx4 v7, s[12:15], s68 offen offset:1024 lds
    buffer_load_dwordx4 v8, s[12:15], s68 offen offset:2048 lds
    buffer_load_dwordx4 v9, s[12:15], s68 offen offset:3072 lds
    s_add_u32 m0, s57, 0x4000
    s_nop 0
    buffer_load_dwordx4 v6, s[12:15], s69 offen offset:0 lds
    buffer_load_dwordx4 v7, s[12:15], s69 offen offset:1024 lds
    buffer_load_dwordx4 v8, s[12:15], s69 offen offset:2048 lds
    buffer_load_dwordx4 v9, s[12:15], s69 offen offset:3072 lds
    s_add_u32 m0, s57, 0x8000
    s_nop 0
    buffer_load_dwordx4 v6, s[12:15], s70 offen offset:0 lds
    buffer_load_dwordx4 v7, s[12:15], s70 offen offset:1024 lds
    buffer_load_dwordx4 v8, s[12:15], s70 offen offset:2048 lds
    buffer_load_dwordx4 v9, s[12:15], s70 offen offset:3072 lds
    s_add_u32 m0, s57, 0xc000
    s_nop 0
    buffer_load_dwordx4 v6, s[12:15], s71 offen offset:0 lds
    buffer_load_dwordx4 v7, s[12:15], s71 offen offset:1024 lds
    buffer_load_dwordx4 v8, s[12:15], s71 offen offset:2048 lds
    buffer_load_dwordx4 v9, s[12:15], s71 offen offset:3072 lds
    v_lshrrev_b32 v11, 5, v2
    v_bfe_u32 v12, v2, 2, 2
    v_lshlrev_b32 v13, 2, v11
    v_add_u32 v13, v13, v12
    v_lshlrev_b32 v13, 7, v13
    v_lshrrev_b32 v12, 1, v12
    v_lshlrev_b32 v12, 6, v12
    v_add_u32 v13, v13, v12
    v_bfe_u32 v12, v2, 4, 1
    v_lshlrev_b32 v12, 5, v12
    v_add_u32 v13, v13, v12
    v_and_b32 v12, 3, v2
    v_lshlrev_b32 v12, 3, v12
    v_add_u32 v13, v13, v12
    v_xor_b32 v14, 64, v13
    v_add_u32 v4, 0x10000, v13
    v_add_u32 v5, 0x10000, v14
    s_barrier
    s_waitcnt vmcnt(0)
    s_barrier
    buffer_load_dwordx4 v[48:51], v3, s[20:23], s60 offen offset:0 sc1
    buffer_load_dwordx4 v[52:55], v3, s[20:23], s60 offen offset:1024 sc1
    buffer_load_dwordx4 v[56:59], v3, s[20:23], s60 offen offset:2048 sc1
    buffer_load_dwordx4 v[60:63], v3, s[20:23], s60 offen offset:3072 sc1
    buffer_load_dwordx4 v[64:67], v10, s[20:23], s60 offen offset:0 sc1
    buffer_load_dwordx4 v[68:71], v10, s[20:23], s60 offen offset:1024 sc1
    buffer_load_dwordx4 v[72:75], v10, s[20:23], s60 offen offset:2048 sc1
    buffer_load_dwordx4 v[76:79], v10, s[20:23], s60 offen offset:3072 sc1
    buffer_load_dwordx4 v[80:83], v3, s[20:23], s61 offen offset:0 sc1
    buffer_load_dwordx4 v[84:87], v3, s[20:23], s61 offen offset:1024 sc1
    buffer_load_dwordx4 v[88:91], v3, s[20:23], s61 offen offset:2048 sc1
    ds_read_b64_tr_b16 v[96:97], v13 offset:0
    ds_read_b64_tr_b16 v[98:99], v13 offset:1024
    ds_read_b64_tr_b16 v[100:101], v14 offset:0
    ds_read_b64_tr_b16 v[102:103], v14 offset:1024
    ds_read_b64_tr_b16 v[104:105], v13 offset:2048
    ds_read_b64_tr_b16 v[106:107], v13 offset:3072
    ds_read_b64_tr_b16 v[108:109], v14 offset:2048
    ds_read_b64_tr_b16 v[110:111], v14 offset:3072
    ds_read_b64_tr_b16 v[112:113], v13 offset:4096
    ds_read_b64_tr_b16 v[114:115], v13 offset:5120
    ds_read_b64_tr_b16 v[116:117], v14 offset:4096
    ds_read_b64_tr_b16 v[118:119], v14 offset:5120
    s_waitcnt vmcnt(10) lgkmcnt(8)
    v_mfma_f32_32x32x16_bf16 v[16:31], v[96:99], v[48:51], 0
    v_mfma_f32_32x32x16_bf16 v[32:47], v[100:103], v[48:51], 0
    ds_read_b64_tr_b16 v[120:121], v13 offset:6144
    ds_read_b64_tr_b16 v[122:123], v13 offset:7168
    ds_read_b64_tr_b16 v[124:125], v14 offset:6144
    ds_read_b64_tr_b16 v[126:127], v14 offset:7168
    buffer_load_dwordx4 v[92:95], v3, s[20:23], s61 offen offset:3072 sc1
    s_waitcnt vmcnt(10) lgkmcnt(8)
    v_mfma_f32_32x32x16_bf16 v[16:31], v[104:107], v[52:55], v[16:31]
    v_mfma_f32_32x32x16_bf16 v[32:47], v[108:111], v[52:55], v[32:47]
    ds_read_b64_tr_b16 v[96:97], v13 offset:8192
    ds_read_b64_tr_b16 v[98:99], v13 offset:9216
    ds_read_b64_tr_b16 v[100:101], v14 offset:8192
    ds_read_b64_tr_b16 v[102:103], v14 offset:9216
    buffer_load_dwordx4 v[48:51], v10, s[20:23], s61 offen offset:0 sc1
    s_waitcnt vmcnt(10) lgkmcnt(8)
    v_mfma_f32_32x32x16_bf16 v[16:31], v[112:115], v[56:59], v[16:31]
    v_mfma_f32_32x32x16_bf16 v[32:47], v[116:119], v[56:59], v[32:47]
    ds_read_b64_tr_b16 v[104:105], v13 offset:10240
    ds_read_b64_tr_b16 v[106:107], v13 offset:11264
    ds_read_b64_tr_b16 v[108:109], v14 offset:10240
    ds_read_b64_tr_b16 v[110:111], v14 offset:11264
    buffer_load_dwordx4 v[52:55], v10, s[20:23], s61 offen offset:1024 sc1
    s_waitcnt vmcnt(10) lgkmcnt(8)
    v_mfma_f32_32x32x16_bf16 v[16:31], v[120:123], v[60:63], v[16:31]
    v_mfma_f32_32x32x16_bf16 v[32:47], v[124:127], v[60:63], v[32:47]
    ds_read_b64_tr_b16 v[112:113], v13 offset:12288
    ds_read_b64_tr_b16 v[114:115], v13 offset:13312
    ds_read_b64_tr_b16 v[116:117], v14 offset:12288
    ds_read_b64_tr_b16 v[118:119], v14 offset:13312
    buffer_load_dwordx4 v[56:59], v10, s[20:23], s61 offen offset:2048 sc1
    s_waitcnt vmcnt(10) lgkmcnt(8)
    v_mfma_f32_32x32x16_bf16 v[16:31], v[96:99], v[64:67], v[16:31]
    v_mfma_f32_32x32x16_bf16 v[32:47], v[100:103], v[64:67], v[32:47]
    ds_read_b64_tr_b16 v[120:121], v13 offset:14336
    ds_read_b64_tr_b16 v[122:123], v13 offset:15360
    ds_read_b64_tr_b16 v[124:125], v14 offset:14336
    ds_read_b64_tr_b16 v[126:127], v14 offset:15360
    buffer_load_dwordx4 v[60:63], v10, s[20:23], s61 offen offset:3072 sc1
    s_waitcnt vmcnt(10) lgkmcnt(8)
    v_mfma_f32_32x32x16_bf16 v[16:31], v[104:107], v[68:71], v[16:31]
    v_mfma_f32_32x32x16_bf16 v[32:47], v[108:111], v[68:71], v[32:47]
    s_barrier
    ds_read_b64_tr_b16 v[96:97], v13 offset:16384
    ds_read_b64_tr_b16 v[98:99], v13 offset:17408
    ds_read_b64_tr_b16 v[100:101], v14 offset:16384
    ds_read_b64_tr_b16 v[102:103], v14 offset:17408
    buffer_load_dwordx4 v[64:67], v3, s[20:23], s62 offen offset:0 sc1
    s_waitcnt vmcnt(10) lgkmcnt(8)
    v_mfma_f32_32x32x16_bf16 v[16:31], v[112:115], v[72:75], v[16:31]
    v_mfma_f32_32x32x16_bf16 v[32:47], v[116:119], v[72:75], v[32:47]
    ds_read_b64_tr_b16 v[104:105], v13 offset:18432
    ds_read_b64_tr_b16 v[106:107], v13 offset:19456
    ds_read_b64_tr_b16 v[108:109], v14 offset:18432
    ds_read_b64_tr_b16 v[110:111], v14 offset:19456
    buffer_load_dwordx4 v[68:71], v3, s[20:23], s62 offen offset:1024 sc1
    s_waitcnt vmcnt(10) lgkmcnt(8)
    v_mfma_f32_32x32x16_bf16 v[16:31], v[120:123], v[76:79], v[16:31]
    v_mfma_f32_32x32x16_bf16 v[32:47], v[124:127], v[76:79], v[32:47]
    ds_read_b64_tr_b16 v[112:113], v13 offset:20480
    ds_read_b64_tr_b16 v[114:115], v13 offset:21504
    ds_read_b64_tr_b16 v[116:117], v14 offset:20480
    ds_read_b64_tr_b16 v[118:119], v14 offset:21504
    buffer_load_dwordx4 v[72:75], v3, s[20:23], s62 offen offset:2048 sc1
    s_waitcnt vmcnt(10) lgkmcnt(8)
    v_mfma_f32_32x32x16_bf16 v[16:31], v[96:99], v[80:83], v[16:31]
    v_mfma_f32_32x32x16_bf16 v[32:47], v[100:103], v[80:83], v[32:47]
    ds_read_b64_tr_b16 v[120:121], v13 offset:22528
    ds_read_b64_tr_b16 v[122:123], v13 offset:23552
    ds_read_b64_tr_b16 v[124:125], v14 offset:22528
    ds_read_b64_tr_b16 v[126:127], v14 offset:23552
    buffer_load_dwordx4 v[76:79], v3, s[20:23], s62 offen offset:3072 sc1
    s_waitcnt vmcnt(10) lgkmcnt(8)
    v_mfma_f32_32x32x16_bf16 v[16:31], v[104:107], v[84:87], v[16:31]
    v_mfma_f32_32x32x16_bf16 v[32:47], v[108:111], v[84:87], v[32:47]
    ds_read_b64_tr_b16 v[96:97], v13 offset:24576
    ds_read_b64_tr_b16 v[98:99], v13 offset:25600
    ds_read_b64_tr_b16 v[100:101], v14 offset:24576
    ds_read_b64_tr_b16 v[102:103], v14 offset:25600
    buffer_load_dwordx4 v[80:83], v10, s[20:23], s62 offen offset:0 sc1
    s_waitcnt vmcnt(10) lgkmcnt(8)
    v_mfma_f32_32x32x16_bf16 v[16:31], v[112:115], v[88:91], v[16:31]
    v_mfma_f32_32x32x16_bf16 v[32:47], v[116:119], v[88:91], v[32:47]
    ds_read_b64_tr_b16 v[104:105], v13 offset:26624
    ds_read_b64_tr_b16 v[106:107], v13 offset:27648
    ds_read_b64_tr_b16 v[108:109], v14 offset:26624
    ds_read_b64_tr_b16 v[110:111], v14 offset:27648
    buffer_load_dwordx4 v[84:87], v10, s[20:23], s62 offen offset:1024 sc1
    s_waitcnt vmcnt(10) lgkmcnt(8)
    v_mfma_f32_32x32x16_bf16 v[16:31], v[120:123], v[92:95], v[16:31]
    v_mfma_f32_32x32x16_bf16 v[32:47], v[124:127], v[92:95], v[32:47]
    ds_read_b64_tr_b16 v[112:113], v13 offset:28672
    ds_read_b64_tr_b16 v[114:115], v13 offset:29696
    ds_read_b64_tr_b16 v[116:117], v14 offset:28672
    ds_read_b64_tr_b16 v[118:119], v14 offset:29696
    buffer_load_dwordx4 v[88:91], v10, s[20:23], s62 offen offset:2048 sc1
    s_waitcnt vmcnt(10) lgkmcnt(8)
    v_mfma_f32_32x32x16_bf16 v[16:31], v[96:99], v[48:51], v[16:31]
    v_mfma_f32_32x32x16_bf16 v[32:47], v[100:103], v[48:51], v[32:47]
    ds_read_b64_tr_b16 v[120:121], v13 offset:30720
    ds_read_b64_tr_b16 v[122:123], v13 offset:31744
    ds_read_b64_tr_b16 v[124:125], v14 offset:30720
    ds_read_b64_tr_b16 v[126:127], v14 offset:31744
    buffer_load_dwordx4 v[92:95], v10, s[20:23], s62 offen offset:3072 sc1
    s_waitcnt vmcnt(10) lgkmcnt(8)
    v_mfma_f32_32x32x16_bf16 v[16:31], v[104:107], v[52:55], v[16:31]
    v_mfma_f32_32x32x16_bf16 v[32:47], v[108:111], v[52:55], v[32:47]
    s_barrier
    ds_read_b64_tr_b16 v[96:97], v13 offset:32768
    ds_read_b64_tr_b16 v[98:99], v13 offset:33792
    ds_read_b64_tr_b16 v[100:101], v14 offset:32768
    ds_read_b64_tr_b16 v[102:103], v14 offset:33792
    buffer_load_dwordx4 v[48:51], v3, s[20:23], s63 offen offset:0 sc1
    s_waitcnt vmcnt(10) lgkmcnt(8)
    v_mfma_f32_32x32x16_bf16 v[16:31], v[112:115], v[56:59], v[16:31]
    v_mfma_f32_32x32x16_bf16 v[32:47], v[116:119], v[56:59], v[32:47]
    ds_read_b64_tr_b16 v[104:105], v13 offset:34816
    ds_read_b64_tr_b16 v[106:107], v13 offset:35840
    ds_read_b64_tr_b16 v[108:109], v14 offset:34816
    ds_read_b64_tr_b16 v[110:111], v14 offset:35840
    buffer_load_dwordx4 v[52:55], v3, s[20:23], s63 offen offset:1024 sc1
    s_waitcnt vmcnt(10) lgkmcnt(8)
    v_mfma_f32_32x32x16_bf16 v[16:31], v[120:123], v[60:63], v[16:31]
    v_mfma_f32_32x32x16_bf16 v[32:47], v[124:127], v[60:63], v[32:47]
    ds_read_b64_tr_b16 v[112:113], v13 offset:36864
    ds_read_b64_tr_b16 v[114:115], v13 offset:37888
    ds_read_b64_tr_b16 v[116:117], v14 offset:36864
    ds_read_b64_tr_b16 v[118:119], v14 offset:37888
    buffer_load_dwordx4 v[56:59], v3, s[20:23], s63 offen offset:2048 sc1
    s_waitcnt vmcnt(10) lgkmcnt(8)
    v_mfma_f32_32x32x16_bf16 v[16:31], v[96:99], v[64:67], v[16:31]
    v_mfma_f32_32x32x16_bf16 v[32:47], v[100:103], v[64:67], v[32:47]
    ds_read_b64_tr_b16 v[120:121], v13 offset:38912
    ds_read_b64_tr_b16 v[122:123], v13 offset:39936
    ds_read_b64_tr_b16 v[124:125], v14 offset:38912
    ds_read_b64_tr_b16 v[126:127], v14 offset:39936
    buffer_load_dwordx4 v[60:63], v3, s[20:23], s63 offen offset:3072 sc1
    s_waitcnt vmcnt(10) lgkmcnt(8)
    v_mfma_f32_32x32x16_bf16 v[16:31], v[104:107], v[68:71], v[16:31]
    v_mfma_f32_32x32x16_bf16 v[32:47], v[108:111], v[68:71], v[32:47]
    ds_read_b64_tr_b16 v[96:97], v13 offset:40960
    ds_read_b64_tr_b16 v[98:99], v13 offset:41984
    ds_read_b64_tr_b16 v[100:101], v14 offset:40960
    ds_read_b64_tr_b16 v[102:103], v14 offset:41984
    buffer_load_dwordx4 v[64:67], v10, s[20:23], s63 offen offset:0 sc1
    s_waitcnt vmcnt(10) lgkmcnt(8)
    v_mfma_f32_32x32x16_bf16 v[16:31], v[112:115], v[72:75], v[16:31]
    v_mfma_f32_32x32x16_bf16 v[32:47], v[116:119], v[72:75], v[32:47]
    ds_read_b64_tr_b16 v[104:105], v13 offset:43008
    ds_read_b64_tr_b16 v[106:107], v13 offset:44032
    ds_read_b64_tr_b16 v[108:109], v14 offset:43008
    ds_read_b64_tr_b16 v[110:111], v14 offset:44032
    s_add_u32 m0, s57, 0x10000
    s_nop 0
    buffer_load_dwordx4 v6, s[12:15], s72 offen offset:0 lds
    buffer_load_dwordx4 v7, s[12:15], s72 offen offset:1024 lds
    buffer_load_dwordx4 v8, s[12:15], s72 offen offset:2048 lds
    s_waitcnt vmcnt(12) lgkmcnt(8)
    v_mfma_f32_32x32x16_bf16 v[16:31], v[120:123], v[76:79], v[16:31]
    v_mfma_f32_32x32x16_bf16 v[32:47], v[124:127], v[76:79], v[32:47]
    ds_read_b64_tr_b16 v[112:113], v13 offset:45056
    ds_read_b64_tr_b16 v[114:115], v13 offset:46080
    ds_read_b64_tr_b16 v[116:117], v14 offset:45056
    ds_read_b64_tr_b16 v[118:119], v14 offset:46080
    buffer_load_dwordx4 v9, s[12:15], s72 offen offset:3072 lds
    buffer_load_dwordx4 v[68:71], v10, s[20:23], s63 offen offset:1024 sc1
    buffer_load_dwordx4 v[72:75], v10, s[20:23], s63 offen offset:2048 sc1
    s_waitcnt vmcnt(14) lgkmcnt(8)
    v_mfma_f32_32x32x16_bf16 v[16:31], v[96:99], v[80:83], v[16:31]
    v_mfma_f32_32x32x16_bf16 v[32:47], v[100:103], v[80:83], v[32:47]
    ds_read_b64_tr_b16 v[120:121], v13 offset:47104
    ds_read_b64_tr_b16 v[122:123], v13 offset:48128
    ds_read_b64_tr_b16 v[124:125], v14 offset:47104
    ds_read_b64_tr_b16 v[126:127], v14 offset:48128
    buffer_load_dwordx4 v[76:79], v10, s[20:23], s63 offen offset:3072 sc1
    s_waitcnt vmcnt(14) lgkmcnt(8)
    v_mfma_f32_32x32x16_bf16 v[16:31], v[104:107], v[84:87], v[16:31]
    v_mfma_f32_32x32x16_bf16 v[32:47], v[108:111], v[84:87], v[32:47]
    s_barrier
    ds_read_b64_tr_b16 v[96:97], v13 offset:49152
    ds_read_b64_tr_b16 v[98:99], v13 offset:50176
    ds_read_b64_tr_b16 v[100:101], v14 offset:49152
    ds_read_b64_tr_b16 v[102:103], v14 offset:50176
    buffer_load_dwordx4 v[80:83], v3, s[20:23], s64 offen offset:0 sc1
    s_waitcnt vmcnt(14) lgkmcnt(8)
    v_mfma_f32_32x32x16_bf16 v[16:31], v[112:115], v[88:91], v[16:31]
    v_mfma_f32_32x32x16_bf16 v[32:47], v[116:119], v[88:91], v[32:47]
    ds_read_b64_tr_b16 v[104:105], v13 offset:51200
    ds_read_b64_tr_b16 v[106:107], v13 offset:52224
    ds_read_b64_tr_b16 v[108:109], v14 offset:51200
    ds_read_b64_tr_b16 v[110:111], v14 offset:52224
    buffer_load_dwordx4 v[84:87], v3, s[20:23], s64 offen offset:1024 sc1
    s_waitcnt vmcnt(14) lgkmcnt(8)
    v_mfma_f32_32x32x16_bf16 v[16:31], v[120:123], v[92:95], v[16:31]
    v_mfma_f32_32x32x16_bf16 v[32:47], v[124:127], v[92:95], v[32:47]
    ds_read_b64_tr_b16 v[112:113], v13 offset:53248
    ds_read_b64_tr_b16 v[114:115], v13 offset:54272
    ds_read_b64_tr_b16 v[116:117], v14 offset:53248
    ds_read_b64_tr_b16 v[118:119], v14 offset:54272
    buffer_load_dwordx4 v[88:91], v3, s[20:23], s64 offen offset:2048 sc1
    s_waitcnt vmcnt(14) lgkmcnt(8)
    v_mfma_f32_32x32x16_bf16 v[16:31], v[96:99], v[48:51], v[16:31]
    v_mfma_f32_32x32x16_bf16 v[32:47], v[100:103], v[48:51], v[32:47]
    ds_read_b64_tr_b16 v[120:121], v13 offset:55296
    ds_read_b64_tr_b16 v[122:123], v13 offset:56320
    ds_read_b64_tr_b16 v[124:125], v14 offset:55296
    ds_read_b64_tr_b16 v[126:127], v14 offset:56320
    buffer_load_dwordx4 v[92:95], v3, s[20:23], s64 offen offset:3072 sc1
    s_waitcnt vmcnt(14) lgkmcnt(8)
    v_mfma_f32_32x32x16_bf16 v[16:31], v[104:107], v[52:55], v[16:31]
    v_mfma_f32_32x32x16_bf16 v[32:47], v[108:111], v[52:55], v[32:47]
    ds_read_b64_tr_b16 v[96:97], v13 offset:57344
    ds_read_b64_tr_b16 v[98:99], v13 offset:58368
    ds_read_b64_tr_b16 v[100:101], v14 offset:57344
    ds_read_b64_tr_b16 v[102:103], v14 offset:58368
    buffer_load_dwordx4 v[48:51], v10, s[20:23], s64 offen offset:0 sc1
    s_waitcnt vmcnt(14) lgkmcnt(8)
    v_mfma_f32_32x32x16_bf16 v[16:31], v[112:115], v[56:59], v[16:31]
    v_mfma_f32_32x32x16_bf16 v[32:47], v[116:119], v[56:59], v[32:47]
    ds_read_b64_tr_b16 v[104:105], v13 offset:59392
    ds_read_b64_tr_b16 v[106:107], v13 offset:60416
    ds_read_b64_tr_b16 v[108:109], v14 offset:59392
    ds_read_b64_tr_b16 v[110:111], v14 offset:60416
    buffer_load_dwordx4 v[52:55], v10, s[20:23], s64 offen offset:1024 sc1
    s_waitcnt vmcnt(14) lgkmcnt(8)
    v_mfma_f32_32x32x16_bf16 v[16:31], v[120:123], v[60:63], v[16:31]
    v_mfma_f32_32x32x16_bf16 v[32:47], v[124:127], v[60:63], v[32:47]
    ds_read_b64_tr_b16 v[112:113], v13 offset:61440
    ds_read_b64_tr_b16 v[114:115], v13 offset:62464
    ds_read_b64_tr_b16 v[116:117], v14 offset:61440
    ds_read_b64_tr_b16 v[118:119], v14 offset:62464
    buffer_load_dwordx4 v[56:59], v10, s[20:23], s64 offen offset:2048 sc1
    s_waitcnt vmcnt(14) lgkmcnt(8)
    v_mfma_f32_32x32x16_bf16 v[16:31], v[96:99], v[64:67], v[16:31]
    v_mfma_f32_32x32x16_bf16 v[32:47], v[100:103], v[64:67], v[32:47]
    ds_read_b64_tr_b16 v[120:121], v13 offset:63488
    ds_read_b64_tr_b16 v[122:123], v13 offset:64512
    ds_read_b64_tr_b16 v[124:125], v14 offset:63488
    ds_read_b64_tr_b16 v[126:127], v14 offset:64512
    buffer_load_dwordx4 v[60:63], v10, s[20:23], s64 offen offset:3072 sc1
    s_waitcnt vmcnt(10) lgkmcnt(8)
    v_mfma_f32_32x32x16_bf16 v[16:31], v[104:107], v[68:71], v[16:31]
    v_mfma_f32_32x32x16_bf16 v[32:47], v[108:111], v[68:71], v[32:47]
    s_barrier
    ds_read_b64_tr_b16 v[96:97], v4 offset:0
    ds_read_b64_tr_b16 v[98:99], v4 offset:1024
    ds_read_b64_tr_b16 v[100:101], v5 offset:0
    ds_read_b64_tr_b16 v[102:103], v5 offset:1024
    buffer_load_dwordx4 v[64:67], v3, s[20:23], s65 offen offset:0 sc1
    s_waitcnt vmcnt(10) lgkmcnt(8)
    v_mfma_f32_32x32x16_bf16 v[16:31], v[112:115], v[72:75], v[16:31]
    v_mfma_f32_32x32x16_bf16 v[32:47], v[116:119], v[72:75], v[32:47]
    ds_read_b64_tr_b16 v[104:105], v4 offset:2048
    ds_read_b64_tr_b16 v[106:107], v4 offset:3072
    ds_read_b64_tr_b16 v[108:109], v5 offset:2048
    ds_read_b64_tr_b16 v[110:111], v5 offset:3072
    buffer_load_dwordx4 v[68:71], v3, s[20:23], s65 offen offset:1024 sc1
    s_waitcnt vmcnt(10) lgkmcnt(8)
    v_mfma_f32_32x32x16_bf16 v[16:31], v[120:123], v[76:79], v[16:31]
    v_mfma_f32_32x32x16_bf16 v[32:47], v[124:127], v[76:79], v[32:47]
    ds_read_b64_tr_b16 v[112:113], v4 offset:4096
    ds_read_b64_tr_b16 v[114:115], v4 offset:5120
    ds_read_b64_tr_b16 v[116:117], v5 offset:4096
    ds_read_b64_tr_b16 v[118:119], v5 offset:5120
    buffer_load_dwordx4 v[72:75], v3, s[20:23], s65 offen offset:2048 sc1
    s_waitcnt vmcnt(10) lgkmcnt(8)
    v_mfma_f32_32x32x16_bf16 v[16:31], v[96:99], v[80:83], v[16:31]
    v_mfma_f32_32x32x16_bf16 v[32:47], v[100:103], v[80:83], v[32:47]
    ds_read_b64_tr_b16 v[120:121], v4 offset:6144
    ds_read_b64_tr_b16 v[122:123], v4 offset:7168
    ds_read_b64_tr_b16 v[124:125], v5 offset:6144
    ds_read_b64_tr_b16 v[126:127], v5 offset:7168
    buffer_load_dwordx4 v[76:79], v3, s[20:23], s65 offen offset:3072 sc1
    s_waitcnt vmcnt(10) lgkmcnt(8)
    v_mfma_f32_32x32x16_bf16 v[16:31], v[104:107], v[84:87], v[16:31]
    v_mfma_f32_32x32x16_bf16 v[32:47], v[108:111], v[84:87], v[32:47]
    ds_read_b64_tr_b16 v[96:97], v4 offset:8192
    ds_read_b64_tr_b16 v[98:99], v4 offset:9216
    ds_read_b64_tr_b16 v[100:101], v5 offset:8192
    ds_read_b64_tr_b16 v[102:103], v5 offset:9216
    buffer_load_dwordx4 v[80:83], v10, s[20:23], s65 offen offset:0 sc1
    s_waitcnt vmcnt(10) lgkmcnt(8)
    v_mfma_f32_32x32x16_bf16 v[16:31], v[112:115], v[88:91], v[16:31]
    v_mfma_f32_32x32x16_bf16 v[32:47], v[116:119], v[88:91], v[32:47]
    ds_read_b64_tr_b16 v[104:105], v4 offset:10240
    ds_read_b64_tr_b16 v[106:107], v4 offset:11264
    ds_read_b64_tr_b16 v[108:109], v5 offset:10240
    ds_read_b64_tr_b16 v[110:111], v5 offset:11264
    buffer_load_dwordx4 v[84:87], v10, s[20:23], s65 offen offset:1024 sc1
    s_waitcnt vmcnt(10) lgkmcnt(8)
    v_mfma_f32_32x32x16_bf16 v[16:31], v[120:123], v[92:95], v[16:31]
    v_mfma_f32_32x32x16_bf16 v[32:47], v[124:127], v[92:95], v[32:47]
    ds_read_b64_tr_b16 v[112:113], v4 offset:12288
    ds_read_b64_tr_b16 v[114:115], v4 offset:13312
    ds_read_b64_tr_b16 v[116:117], v5 offset:12288
    ds_read_b64_tr_b16 v[118:119], v5 offset:13312
    buffer_load_dwordx4 v[88:91], v10, s[20:23], s65 offen offset:2048 sc1
    s_waitcnt vmcnt(10) lgkmcnt(8)
    v_mfma_f32_32x32x16_bf16 v[16:31], v[96:99], v[48:51], v[16:31]
    v_mfma_f32_32x32x16_bf16 v[32:47], v[100:103], v[48:51], v[32:47]
    ds_read_b64_tr_b16 v[120:121], v4 offset:14336
    ds_read_b64_tr_b16 v[122:123], v4 offset:15360
    ds_read_b64_tr_b16 v[124:125], v5 offset:14336
    ds_read_b64_tr_b16 v[126:127], v5 offset:15360
    buffer_load_dwordx4 v[92:95], v10, s[20:23], s65 offen offset:3072 sc1
    s_waitcnt vmcnt(10) lgkmcnt(8)
    v_mfma_f32_32x32x16_bf16 v[16:31], v[104:107], v[52:55], v[16:31]
    v_mfma_f32_32x32x16_bf16 v[32:47], v[108:111], v[52:55], v[32:47]
    s_barrier
    ds_read_b64_tr_b16 v[96:97], v13 offset:0
    ds_read_b64_tr_b16 v[98:99], v13 offset:1024
    ds_read_b64_tr_b16 v[100:101], v14 offset:0
    ds_read_b64_tr_b16 v[102:103], v14 offset:1024
    buffer_load_dwordx4 v[48:51], v3, s[20:23], s66 offen offset:0 sc1
    s_waitcnt vmcnt(10) lgkmcnt(8)
    v_mfma_f32_32x32x16_bf16 v[16:31], v[112:115], v[56:59], v[16:31]
    v_mfma_f32_32x32x16_bf16 v[32:47], v[116:119], v[56:59], v[32:47]
    ds_read_b64_tr_b16 v[104:105], v13 offset:2048
    ds_read_b64_tr_b16 v[106:107], v13 offset:3072
    ds_read_b64_tr_b16 v[108:109], v14 offset:2048
    ds_read_b64_tr_b16 v[110:111], v14 offset:3072
    buffer_load_dwordx4 v[52:55], v3, s[20:23], s66 offen offset:1024 sc1
    s_waitcnt vmcnt(10) lgkmcnt(8)
    v_mfma_f32_32x32x16_bf16 v[16:31], v[120:123], v[60:63], v[16:31]
    v_mfma_f32_32x32x16_bf16 v[32:47], v[124:127], v[60:63], v[32:47]
    ds_read_b64_tr_b16 v[112:113], v13 offset:4096
    ds_read_b64_tr_b16 v[114:115], v13 offset:5120
    ds_read_b64_tr_b16 v[116:117], v14 offset:4096
    ds_read_b64_tr_b16 v[118:119], v14 offset:5120
    buffer_load_dwordx4 v[56:59], v3, s[20:23], s66 offen offset:2048 sc1
    s_waitcnt vmcnt(10) lgkmcnt(8)
    v_mfma_f32_32x32x16_bf16 v[16:31], v[96:99], v[64:67], v[16:31]
    v_mfma_f32_32x32x16_bf16 v[32:47], v[100:103], v[64:67], v[32:47]
    ds_read_b64_tr_b16 v[120:121], v13 offset:6144
    ds_read_b64_tr_b16 v[122:123], v13 offset:7168
    ds_read_b64_tr_b16 v[124:125], v14 offset:6144
    ds_read_b64_tr_b16 v[126:127], v14 offset:7168
    buffer_load_dwordx4 v[60:63], v3, s[20:23], s66 offen offset:3072 sc1
    s_waitcnt vmcnt(10) lgkmcnt(8)
    v_mfma_f32_32x32x16_bf16 v[16:31], v[104:107], v[68:71], v[16:31]
    v_mfma_f32_32x32x16_bf16 v[32:47], v[108:111], v[68:71], v[32:47]
    ds_read_b64_tr_b16 v[96:97], v13 offset:8192
    ds_read_b64_tr_b16 v[98:99], v13 offset:9216
    ds_read_b64_tr_b16 v[100:101], v14 offset:8192
    ds_read_b64_tr_b16 v[102:103], v14 offset:9216
    buffer_load_dwordx4 v[64:67], v10, s[20:23], s66 offen offset:0 sc1
    s_waitcnt vmcnt(10) lgkmcnt(8)
    v_mfma_f32_32x32x16_bf16 v[16:31], v[112:115], v[72:75], v[16:31]
    v_mfma_f32_32x32x16_bf16 v[32:47], v[116:119], v[72:75], v[32:47]
    ds_read_b64_tr_b16 v[104:105], v13 offset:10240
    ds_read_b64_tr_b16 v[106:107], v13 offset:11264
    ds_read_b64_tr_b16 v[108:109], v14 offset:10240
    ds_read_b64_tr_b16 v[110:111], v14 offset:11264
    buffer_load_dwordx4 v[68:71], v10, s[20:23], s66 offen offset:1024 sc1
    s_waitcnt vmcnt(10) lgkmcnt(8)
    v_mfma_f32_32x32x16_bf16 v[16:31], v[120:123], v[76:79], v[16:31]
    v_mfma_f32_32x32x16_bf16 v[32:47], v[124:127], v[76:79], v[32:47]
    ds_read_b64_tr_b16 v[112:113], v13 offset:12288
    ds_read_b64_tr_b16 v[114:115], v13 offset:13312
    ds_read_b64_tr_b16 v[116:117], v14 offset:12288
    ds_read_b64_tr_b16 v[118:119], v14 offset:13312
    buffer_load_dwordx4 v[72:75], v10, s[20:23], s66 offen offset:2048 sc1
    s_waitcnt vmcnt(10) lgkmcnt(8)
    v_mfma_f32_32x32x16_bf16 v[16:31], v[96:99], v[80:83], v[16:31]
    v_mfma_f32_32x32x16_bf16 v[32:47], v[100:103], v[80:83], v[32:47]
    ds_read_b64_tr_b16 v[120:121], v13 offset:14336
    ds_read_b64_tr_b16 v[122:123], v13 offset:15360
    ds_read_b64_tr_b16 v[124:125], v14 offset:14336
    ds_read_b64_tr_b16 v[126:127], v14 offset:15360
    buffer_load_dwordx4 v[76:79], v10, s[20:23], s66 offen offset:3072 sc1
    s_waitcnt vmcnt(10) lgkmcnt(8)
    v_mfma_f32_32x32x16_bf16 v[16:31], v[104:107], v[84:87], v[16:31]
    v_mfma_f32_32x32x16_bf16 v[32:47], v[108:111], v[84:87], v[32:47]
    s_barrier
    ds_read_b64_tr_b16 v[96:97], v13 offset:16384
    ds_read_b64_tr_b16 v[98:99], v13 offset:17408
    ds_read_b64_tr_b16 v[100:101], v14 offset:16384
    ds_read_b64_tr_b16 v[102:103], v14 offset:17408
    buffer_load_dwordx4 v[80:83], v3, s[20:23], s67 offen offset:0 sc1
    s_waitcnt vmcnt(10) lgkmcnt(8)
    v_mfma_f32_32x32x16_bf16 v[16:31], v[112:115], v[88:91], v[16:31]
    v_mfma_f32_32x32x16_bf16 v[32:47], v[116:119], v[88:91], v[32:47]
    ds_read_b64_tr_b16 v[104:105], v13 offset:18432
    ds_read_b64_tr_b16 v[106:107], v13 offset:19456
    ds_read_b64_tr_b16 v[108:109], v14 offset:18432
    ds_read_b64_tr_b16 v[110:111], v14 offset:19456
    buffer_load_dwordx4 v[84:87], v3, s[20:23], s67 offen offset:1024 sc1
    s_waitcnt vmcnt(10) lgkmcnt(8)
    v_mfma_f32_32x32x16_bf16 v[16:31], v[120:123], v[92:95], v[16:31]
    v_mfma_f32_32x32x16_bf16 v[32:47], v[124:127], v[92:95], v[32:47]
    ds_read_b64_tr_b16 v[112:113], v13 offset:20480
    ds_read_b64_tr_b16 v[114:115], v13 offset:21504
    ds_read_b64_tr_b16 v[116:117], v14 offset:20480
    ds_read_b64_tr_b16 v[118:119], v14 offset:21504
    buffer_load_dwordx4 v[88:91], v3, s[20:23], s67 offen offset:2048 sc1
    s_waitcnt vmcnt(10) lgkmcnt(8)
    v_mfma_f32_32x32x16_bf16 v[16:31], v[96:99], v[48:51], v[16:31]
    v_mfma_f32_32x32x16_bf16 v[32:47], v[100:103], v[48:51], v[32:47]
    ds_read_b64_tr_b16 v[120:121], v13 offset:22528
    ds_read_b64_tr_b16 v[122:123], v13 offset:23552
    ds_read_b64_tr_b16 v[124:125], v14 offset:22528
    ds_read_b64_tr_b16 v[126:127], v14 offset:23552
    buffer_load_dwordx4 v[92:95], v3, s[20:23], s67 offen offset:3072 sc1
    s_waitcnt vmcnt(10) lgkmcnt(8)
    v_mfma_f32_32x32x16_bf16 v[16:31], v[104:107], v[52:55], v[16:31]
    v_mfma_f32_32x32x16_bf16 v[32:47], v[108:111], v[52:55], v[32:47]
    ds_read_b64_tr_b16 v[96:97], v13 offset:24576
    ds_read_b64_tr_b16 v[98:99], v13 offset:25600
    ds_read_b64_tr_b16 v[100:101], v14 offset:24576
    ds_read_b64_tr_b16 v[102:103], v14 offset:25600
    buffer_load_dwordx4 v[48:51], v10, s[20:23], s67 offen offset:0 sc1
    s_waitcnt vmcnt(10) lgkmcnt(8)
    v_mfma_f32_32x32x16_bf16 v[16:31], v[112:115], v[56:59], v[16:31]
    v_mfma_f32_32x32x16_bf16 v[32:47], v[116:119], v[56:59], v[32:47]
    ds_read_b64_tr_b16 v[104:105], v13 offset:26624
    ds_read_b64_tr_b16 v[106:107], v13 offset:27648
    ds_read_b64_tr_b16 v[108:109], v14 offset:26624
    ds_read_b64_tr_b16 v[110:111], v14 offset:27648
    buffer_load_dwordx4 v[52:55], v10, s[20:23], s67 offen offset:1024 sc1
    s_waitcnt vmcnt(10) lgkmcnt(8)
    v_mfma_f32_32x32x16_bf16 v[16:31], v[120:123], v[60:63], v[16:31]
    v_mfma_f32_32x32x16_bf16 v[32:47], v[124:127], v[60:63], v[32:47]
    ds_read_b64_tr_b16 v[112:113], v13 offset:28672
    ds_read_b64_tr_b16 v[114:115], v13 offset:29696
    ds_read_b64_tr_b16 v[116:117], v14 offset:28672
    ds_read_b64_tr_b16 v[118:119], v14 offset:29696
    buffer_load_dwordx4 v[56:59], v10, s[20:23], s67 offen offset:2048 sc1
    s_waitcnt vmcnt(10) lgkmcnt(8)
    v_mfma_f32_32x32x16_bf16 v[16:31], v[96:99], v[64:67], v[16:31]
    v_mfma_f32_32x32x16_bf16 v[32:47], v[100:103], v[64:67], v[32:47]
    ds_read_b64_tr_b16 v[120:121], v13 offset:30720
    ds_read_b64_tr_b16 v[122:123], v13 offset:31744
    ds_read_b64_tr_b16 v[124:125], v14 offset:30720
    ds_read_b64_tr_b16 v[126:127], v14 offset:31744
    buffer_load_dwordx4 v[60:63], v10, s[20:23], s67 offen offset:3072 sc1
    s_waitcnt vmcnt(10) lgkmcnt(8)
    v_mfma_f32_32x32x16_bf16 v[16:31], v[104:107], v[68:71], v[16:31]
    v_mfma_f32_32x32x16_bf16 v[32:47], v[108:111], v[68:71], v[32:47]
    s_barrier
    ds_read_b64_tr_b16 v[96:97], v13 offset:32768
    ds_read_b64_tr_b16 v[98:99], v13 offset:33792
    ds_read_b64_tr_b16 v[100:101], v14 offset:32768
    ds_read_b64_tr_b16 v[102:103], v14 offset:33792
    s_waitcnt vmcnt(9) lgkmcnt(8)
    v_mfma_f32_32x32x16_bf16 v[16:31], v[112:115], v[72:75], v[16:31]
    v_mfma_f32_32x32x16_bf16 v[32:47], v[116:119], v[72:75], v[32:47]
    ds_read_b64_tr_b16 v[104:105], v13 offset:34816
    ds_read_b64_tr_b16 v[106:107], v13 offset:35840
    ds_read_b64_tr_b16 v[108:109], v14 offset:34816
    ds_read_b64_tr_b16 v[110:111], v14 offset:35840
    s_waitcnt vmcnt(8) lgkmcnt(8)
    v_mfma_f32_32x32x16_bf16 v[16:31], v[120:123], v[76:79], v[16:31]
    v_mfma_f32_32x32x16_bf16 v[32:47], v[124:127], v[76:79], v[32:47]
    ds_read_b64_tr_b16 v[112:113], v13 offset:36864
    ds_read_b64_tr_b16 v[114:115], v13 offset:37888
    ds_read_b64_tr_b16 v[116:117], v14 offset:36864
    ds_read_b64_tr_b16 v[118:119], v14 offset:37888
    s_waitcnt vmcnt(7) lgkmcnt(8)
    v_mfma_f32_32x32x16_bf16 v[16:31], v[96:99], v[80:83], v[16:31]
    v_mfma_f32_32x32x16_bf16 v[32:47], v[100:103], v[80:83], v[32:47]
    ds_read_b64_tr_b16 v[120:121], v13 offset:38912
    ds_read_b64_tr_b16 v[122:123], v13 offset:39936
    ds_read_b64_tr_b16 v[124:125], v14 offset:38912
    ds_read_b64_tr_b16 v[126:127], v14 offset:39936
    s_waitcnt vmcnt(6) lgkmcnt(8)
    v_mfma_f32_32x32x16_bf16 v[16:31], v[104:107], v[84:87], v[16:31]
    v_mfma_f32_32x32x16_bf16 v[32:47], v[108:111], v[84:87], v[32:47]
    ds_read_b64_tr_b16 v[96:97], v13 offset:40960
    ds_read_b64_tr_b16 v[98:99], v13 offset:41984
    ds_read_b64_tr_b16 v[100:101], v14 offset:40960
    ds_read_b64_tr_b16 v[102:103], v14 offset:41984
    s_waitcnt vmcnt(5) lgkmcnt(8)
    v_mfma_f32_32x32x16_bf16 v[16:31], v[112:115], v[88:91], v[16:31]
    v_mfma_f32_32x32x16_bf16 v[32:47], v[116:119], v[88:91], v[32:47]
    ds_read_b64_tr_b16 v[104:105], v13 offset:43008
    ds_read_b64_tr_b16 v[106:107], v13 offset:44032
    ds_read_b64_tr_b16 v[108:109], v14 offset:43008
    ds_read_b64_tr_b16 v[110:111], v14 offset:44032
    s_waitcnt vmcnt(4) lgkmcnt(8)
    v_mfma_f32_32x32x16_bf16 v[16:31], v[120:123], v[92:95], v[16:31]
    v_mfma_f32_32x32x16_bf16 v[32:47], v[124:127], v[92:95], v[32:47]
    ds_read_b64_tr_b16 v[112:113], v13 offset:45056
    ds_read_b64_tr_b16 v[114:115], v13 offset:46080
    ds_read_b64_tr_b16 v[116:117], v14 offset:45056
    ds_read_b64_tr_b16 v[118:119], v14 offset:46080
    s_waitcnt vmcnt(3) lgkmcnt(8)
    v_mfma_f32_32x32x16_bf16 v[16:31], v[96:99], v[48:51], v[16:31]
    v_mfma_f32_32x32x16_bf16 v[32:47], v[100:103], v[48:51], v[32:47]
    ds_read_b64_tr_b16 v[120:121], v13 offset:47104
    ds_read_b64_tr_b16 v[122:123], v13 offset:48128
    ds_read_b64_tr_b16 v[124:125], v14 offset:47104
    ds_read_b64_tr_b16 v[126:127], v14 offset:48128
    s_waitcnt vmcnt(2) lgkmcnt(8)
    v_mfma_f32_32x32x16_bf16 v[16:31], v[104:107], v[52:55], v[16:31]
    v_mfma_f32_32x32x16_bf16 v[32:47], v[108:111], v[52:55], v[32:47]
    s_waitcnt vmcnt(1) lgkmcnt(4)
    v_mfma_f32_32x32x16_bf16 v[16:31], v[112:115], v[56:59], v[16:31]
    v_mfma_f32_32x32x16_bf16 v[32:47], v[116:119], v[56:59], v[32:47]
    s_waitcnt vmcnt(0) lgkmcnt(0)
    v_mfma_f32_32x32x16_bf16 v[16:31], v[120:123], v[60:63], v[16:31]
    v_mfma_f32_32x32x16_bf16 v[32:47], v[124:127], v[60:63], v[32:47]
    s_nop 15
    v_and_b32 v7, 15, v2
    v_lshlrev_b32 v7, 12, v7
    v_lshlrev_b32 v8, 4, v11
    v_add_u32 v7, v7, v8
    v_bfe_u32 v8, v2, 4, 1
    v_lshlrev_b32 v8, 5, v8
    v_add_u32 v7, v7, v8
    s_lshl_b32 s35, s34, 17
    s_lshl_b32 s36, s26, 7
    s_add_u32 s35, s35, s36
    s_add_u32 s36, s35, 0x10000
    v_cvt_pk_bf16_f32 v16, v16, v17
    v_cvt_pk_bf16_f32 v17, v18, v19
    v_cvt_pk_bf16_f32 v18, v20, v21
    v_cvt_pk_bf16_f32 v19, v22, v23
    v_cvt_pk_bf16_f32 v20, v24, v25
    v_cvt_pk_bf16_f32 v21, v26, v27
    v_cvt_pk_bf16_f32 v22, v28, v29
    v_cvt_pk_bf16_f32 v23, v30, v31
    s_nop 1
    v_permlane32_swap_b32 v16, v18
    v_permlane32_swap_b32 v17, v19
    v_permlane32_swap_b32 v20, v22
    v_permlane32_swap_b32 v21, v23
    s_nop 1
    v_permlane16_swap_b32 v16, v20
    v_permlane16_swap_b32 v17, v21
    v_permlane16_swap_b32 v18, v22
    v_permlane16_swap_b32 v19, v23
    s_nop 1
    buffer_store_dwordx4 v[16:19], v7, s[16:19], s35 offen offset:0 sc1
    buffer_store_dwordx4 v[20:23], v7, s[16:19], s36 offen offset:0 sc1
    v_cvt_pk_bf16_f32 v32, v32, v33
    v_cvt_pk_bf16_f32 v33, v34, v35
    v_cvt_pk_bf16_f32 v34, v36, v37
    v_cvt_pk_bf16_f32 v35, v38, v39
    v_cvt_pk_bf16_f32 v36, v40, v41
    v_cvt_pk_bf16_f32 v37, v42, v43
    v_cvt_pk_bf16_f32 v38, v44, v45
    v_cvt_pk_bf16_f32 v39, v46, v47
    s_nop 1
    v_permlane32_swap_b32 v32, v34
    v_permlane32_swap_b32 v33, v35
    v_permlane32_swap_b32 v36, v38
    v_permlane32_swap_b32 v37, v39
    s_nop 1
    v_permlane16_swap_b32 v32, v36
    v_permlane16_swap_b32 v33, v37
    v_permlane16_swap_b32 v34, v38
    v_permlane16_swap_b32 v35, v39
    s_nop 1
    buffer_store_dwordx4 v[32:35], v7, s[16:19], s35 offen offset:64 sc1
    buffer_store_dwordx4 v[36:39], v7, s[16:19], s36 offen offset:64 sc1
    s_endpgm
K2_END:
    s_endpgm
.section .rodata,"a"
.p2align 6
.amdhsa_kernel k1_qkv_kernel
  .amdhsa_next_free_vgpr 192
  .amdhsa_next_free_sgpr 102
  .amdhsa_accum_offset 192
  .amdhsa_group_segment_fixed_size 0
  .amdhsa_kernarg_size 88
  .amdhsa_user_sgpr_count 2
  .amdhsa_user_sgpr_kernarg_segment_ptr 1
  .amdhsa_system_sgpr_workgroup_id_x 1
.end_amdhsa_kernel
.amdhsa_kernel k2_attn_kernel
  .amdhsa_next_free_vgpr 128
  .amdhsa_next_free_sgpr 102
  .amdhsa_accum_offset 128
  .amdhsa_group_segment_fixed_size 0
  .amdhsa_kernarg_size 88
  .amdhsa_user_sgpr_count 2
  .amdhsa_user_sgpr_kernarg_segment_ptr 1
  .amdhsa_system_sgpr_workgroup_id_x 1
.end_amdhsa_kernel
```
